```python
import torch

def _softmax(x, axis=-1):
    return torch.softmax(x, dim=axis)
def _gelu(x):
    return torch.nn.functional.gelu(x, approximate="tanh")
def _silu(x):
    return torch.nn.functional.silu(x)
def _sigmoid(x):
    return torch.sigmoid(x)
def _layernorm(x, axis=-1, eps=1e-5):
    m = x.mean(dim=axis, keepdim=True)
    v = x.var(dim=axis, keepdim=True, unbiased=False)
    return (x - m) / torch.sqrt(v + eps)
def _scatter_add(tgt, idx, src, axis=0):
    return tgt.clone().index_add_(axis, idx, src)
def _segment_sum(src, seg, n):
    out = torch.zeros((n,) + src.shape[1:], dtype=src.dtype)
    return out.index_add_(0, seg, src)
def _pad(x, pw):
    flat = tuple(v for pair in reversed(pw) for v in pair)
    return torch.nn.functional.pad(x, flat)

kernel_name = 'standalone__attention_interact_autoint__recsys'

def setup_inputs():

    _w = (lambda a: (lambda t: t.to(torch.bfloat16) if t.is_floating_point() else t)(torch.as_tensor(a)))
    B, F = 4096, 100
    D = max(2, (64 // 2) * 2)
    H = 2
    Dh = D // H
    return {
        "e": _w((lambda *s: torch.randn(*s, dtype=torch.bfloat16) * 0.05)(B, F, D).to(float)),
        "wq": _w((lambda *s: torch.randn(*s, dtype=torch.bfloat16) * 3.2)(H, D, Dh).to(float)),
        "wk": _w((lambda *s: torch.randn(*s, dtype=torch.bfloat16) * 3.2)(H, D, Dh).to(float)),
        "wv": _w((lambda *s: torch.randn(*s, dtype=torch.bfloat16) * 0.05)(H, D, Dh).to(float)),
        "wres": _w((lambda *s: torch.randn(*s, dtype=torch.bfloat16) * 0.05)(D, D).to(float)),
    }

def reference(e, wq, wk, wv, wres):
    H, D, Dh = wq.shape[0], wq.shape[1], wq.shape[2]
    B, F = e.shape[0], e.shape[1]
    q = torch.einsum('bfd,hdk->bhfk', e, wq)
    k = torch.einsum('bfd,hdk->bhfk', e, wk)
    v = torch.einsum('bfd,hdk->bhfk', e, wv)
    scale = float(Dh) ** -0.5
    scores = torch.einsum('bhfk,bhgk->bhfg', q, k) * scale
    attn = _softmax(scores, axis=-1)
    attn = (lambda x, dt: x.to(dt))(attn, v.dtype)
    ctx = torch.einsum('bhfg,bhgk->bhfk', attn, v)
    ctx = (lambda x, *d: x.permute(*d))(ctx, 0, 2, 1, 3).reshape(B, F, H * Dh)
    res = torch.einsum('bfd,de->bfe', e, wres)
    out = ctx + res
    mask = (lambda x, dt: x.to(dt))(out > 0, out.dtype)
    return out * mask
```

```asm
; @launch grid=(512,1,1) block=(256,1,1) lds=81920
.amdgcn_target "amdgcn-amd-amdhsa--gfx950"
.text
.globl standalone__attention_interact_autoint__recsys_kernel
.p2align 8
.type standalone__attention_interact_autoint__recsys_kernel,@function
standalone__attention_interact_autoint__recsys_kernel:
    s_cmp_ge_u32 s2, 512
    s_cbranch_scc1 L_done
    s_setprio 3
    v_lshrrev_b32 v1, 6, v0
    s_load_dwordx2 s[4:5], s[0:1], 0
    s_load_dwordx2 s[26:27], s[0:1], 40
    v_readfirstlane_b32 s52, v1
    v_and_b32 v2, 63, v0
    v_and_b32 v1, 1, v1
    v_lshrrev_b32 v3, 4, v2
    s_lshl_b32 s45, s52, 3
    s_add_u32 s20, s0, s45
    s_addc_u32 s21, s1, 0
    s_load_dwordx2 s[6:7], s[20:21], 8
    s_and_b32 s32, s52, 1
    s_lshr_b32 s53, s52, 1
    v_and_b32 v4, 15, v2
    v_lshlrev_b32 v231, 4, v2
    s_mul_i32 s54, s53, 36864
    s_lshl_b32 s45, s32, 10
    s_add_u32 s55, s54, s45
    v_lshrrev_b32 v6, 3, v2
    v_and_b32 v7, 7, v2
    v_lshrrev_b32 v10, 1, v6
    v_xor_b32 v7, v7, v10
    v_lshlrev_b32 v10, 7, v6
    v_lshl_add_u32 v10, v7, 4, v10
    v_lshlrev_b32 v11, 6, v1
    v_xor_b32 v11, v10, v11
    v_lshl_add_u32 v248, v1, 10, v11
    v_and_b32 v7, 3, v4
    s_mov_b32 s45, 13107200
    v_mul_lo_u32 v7, v7, s45
    v_lshrrev_b32 v6, 2, v4
    v_lshl_add_u32 v7, v6, 7, v7
    v_lshl_add_u32 v9, v3, 4, v7
    s_lshl_b32 s33, s2, 1
    s_add_u32 s33, s33, s53
    s_mul_i32 s33, s33, 12800
    s_lshl_b32 s46, s52, 13
    s_add_u32 s46, s46, 12288
    s_cmp_eq_u32 s52, 3
    s_cselect_b32 s46, 49152, s46
    s_mov_b32 s18, 8192
    s_mov_b32 s19, 0x00020000
    s_mov_b32 s10, 52428800
    s_mov_b32 s11, 0x00020000
    s_mov_b32 s14, 52428800
    s_mov_b32 s15, 0x00020000
    s_movk_i32 s47, 4096
    s_mov_b32 m0, s46
    s_add_u32 s39, s33, 12288
    s_waitcnt lgkmcnt(0)
    s_mov_b32 s16, s6
    s_and_b32 s17, s7, 0xffff
    s_mov_b32 s8, s4
    s_and_b32 s9, s5, 0xffff
    s_mov_b32 s12, s26
    s_and_b32 s13, s27, 0xffff
    s_cmp_ge_u32 s2, 256
    s_cbranch_scc1 L_lateW
    s_mov_b32 m0, s46
    s_nop 0
    buffer_load_dwordx4 v231, s[16:19], 0 offen offset:0 lds
    buffer_load_dwordx4 v231, s[16:19], 0 offen offset:1024 lds
    buffer_load_dwordx4 v231, s[16:19], 0 offen offset:2048 lds
    buffer_load_dwordx4 v231, s[16:19], 0 offen offset:3072 lds
    s_add_u32 m0, s46, 4096
    s_nop 0
    buffer_load_dwordx4 v231, s[16:19], s47 offen offset:0 lds
    buffer_load_dwordx4 v231, s[16:19], s47 offen offset:1024 lds
    buffer_load_dwordx4 v231, s[16:19], s47 offen offset:2048 lds
    buffer_load_dwordx4 v231, s[16:19], s47 offen offset:3072 lds
L_lateW:
    v_mov_b32 v230, v9
    s_setprio 2
    s_add_u32 m0, s55, 0
    s_add_u32 s36, s33, 0
    buffer_load_dwordx4 v248, s[8:11], s36 offen nt lds
    buffer_load_dwordx4 v248, s[8:11], s36 offen offset:2048 nt lds
    s_add_u32 m0, s55, 4096
    s_add_u32 s37, s33, 4096
    buffer_load_dwordx4 v248, s[8:11], s37 offen nt lds
    buffer_load_dwordx4 v248, s[8:11], s37 offen offset:2048 nt lds
    s_add_u32 m0, s55, 8192
    s_add_u32 s38, s33, 8192
    buffer_load_dwordx4 v248, s[8:11], s38 offen nt lds
    buffer_load_dwordx4 v248, s[8:11], s38 offen offset:2048 nt lds
    buffer_load_dwordx4 v[222:225], v230, s[8:11], s39 offen
    buffer_load_dwordx4 v[226:229], v230, s[8:11], s39 offen offset:64
    s_setprio 3
    v_lshl_add_u32 v5, v1, 2, v3
    v_and_b32 v6, 7, v4
    v_xor_b32 v5, v5, v6
    v_lshlrev_b32 v5, 4, v5
    v_lshl_add_u32 v5, v4, 7, v5
    v_add_u32 v252, s54, v5
    v_lshlrev_b32 v5, 4, v2
    v_lshl_add_u32 v249, v1, 10, v5
    v_lshrrev_b32 v6, 3, v2
    v_lshlrev_b32 v6, 4, v6
    v_xor_b32 v5, v249, v6
    v_add_u32 v253, s54, v5
    v_lshrrev_b32 v7, 1, v4
    v_xor_b32 v7, v3, v7
    v_lshlrev_b32 v6, 7, v4
    v_lshl_add_u32 v6, v7, 4, v6
    v_add_u32 v246, s54, v6
    v_xor_b32 v247, 64, v246
    s_mul_i32 s45, s52, 896
    s_add_u32 s45, s45, 73728
    v_mul_u32_u24 v6, 224, v3
    v_lshl_add_u32 v6, v4, 1, v6
    v_add_u32 v250, s45, v6
    v_lshrrev_b32 v6, 2, v4
    v_mul_u32_u24 v6, 224, v6
    v_lshl_add_u32 v6, v3, 3, v6
    v_add_u32 v251, s45, v6
    v_mov_b32 v238, 0x3f803f80
    v_mov_b32 v242, 0xc2700000
    s_mov_b32 s56, 0x11111111
    s_mov_b32 s57, 0x11111111
    v_mov_b32 v239, 0x3f803f80
    v_mov_b32 v243, 0xc2700000
    s_mov_b32 s58, 0x22222222
    s_mov_b32 s59, 0x22222222
    v_mov_b32 v240, 0x3f803f80
    v_mov_b32 v244, 0xc2700000
    s_mov_b32 s60, 0x44444444
    s_mov_b32 s61, 0x44444444
    v_mov_b32 v241, 0x3f803f80
    v_mov_b32 v245, 0xc2700000
    s_mov_b32 s62, 0x88888888
    s_mov_b32 s63, 0x88888888
    v_mov_b32 v203, 0
    v_mov_b32 v205, 0
    v_lshrrev_b32 v10, 2, v4
    v_lshl_add_u32 v10, v3, 3, v10
    v_and_b32 v11, 3, v4
    v_lshlrev_b32 v12, 6, v10
    v_lshl_add_u32 v12, v1, 12, v12
    v_add_u32 v12, 12288, v12
    v_lshl_add_u32 v206, v11, 3, v12
    v_lshl_add_u32 v207, v11, 4, v12
    v_lshlrev_b32 v12, 7, v10
    v_lshl_add_u32 v12, v1, 6, v12
    v_lshl_add_u32 v12, v11, 4, v12
    v_add_u32 v208, 49152, v12
    v_mov_b32 v0, 0
    v_mov_b32 v1, 1.0
    s_cmp_ge_u32 s2, 256
    s_cbranch_scc1 L_late1
    s_waitcnt vmcnt(8)
    s_barrier
    s_branch L_late2
L_late1:
    s_mov_b32 m0, s46
    s_nop 0
    buffer_load_dwordx4 v231, s[16:19], 0 offen offset:0 lds
    buffer_load_dwordx4 v231, s[16:19], 0 offen offset:1024 lds
    buffer_load_dwordx4 v231, s[16:19], 0 offen offset:2048 lds
    buffer_load_dwordx4 v231, s[16:19], 0 offen offset:3072 lds
    s_add_u32 m0, s46, 4096
    s_nop 0
    buffer_load_dwordx4 v231, s[16:19], s47 offen offset:0 lds
    buffer_load_dwordx4 v231, s[16:19], s47 offen offset:1024 lds
    buffer_load_dwordx4 v231, s[16:19], s47 offen offset:2048 lds
    buffer_load_dwordx4 v231, s[16:19], s47 offen offset:3072 lds
    s_waitcnt vmcnt(0)
    s_barrier
L_late2:
    ds_read_b64_tr_b16 v[2:3], v206 offset:0
    ds_read_b64_tr_b16 v[4:5], v206 offset:256
    ds_read_b64_tr_b16 v[6:7], v206 offset:32
    ds_read_b64_tr_b16 v[8:9], v206 offset:288
    ds_read_b64_tr_b16 v[10:11], v206 offset:2048
    ds_read_b64_tr_b16 v[12:13], v206 offset:2304
    ds_read_b64_tr_b16 v[14:15], v206 offset:2080
    ds_read_b64_tr_b16 v[16:17], v206 offset:2336
    ds_read_b64_tr_b16 v[18:19], v206 offset:8192
    ds_read_b64_tr_b16 v[20:21], v206 offset:8448
    ds_read_b64_tr_b16 v[22:23], v206 offset:8224
    ds_read_b64_tr_b16 v[24:25], v206 offset:8480
    ds_read_b64_tr_b16 v[26:27], v206 offset:10240
    ds_read_b64_tr_b16 v[28:29], v206 offset:10496
    ds_read_b64_tr_b16 v[30:31], v206 offset:10272
    ds_read_b64_tr_b16 v[32:33], v206 offset:10528
    ds_read_b64_tr_b16 v[34:35], v207 offset:16384
    ds_read_b64_tr_b16 v[36:37], v207 offset:16640
    ds_read_b64_tr_b16 v[38:39], v207 offset:16392
    ds_read_b64_tr_b16 v[40:41], v207 offset:16648
    ds_read_b64_tr_b16 v[42:43], v207 offset:18432
    ds_read_b64_tr_b16 v[44:45], v207 offset:18688
    ds_read_b64_tr_b16 v[46:47], v207 offset:18440
    ds_read_b64_tr_b16 v[48:49], v207 offset:18696
    ds_read_b64_tr_b16 v[50:51], v208 offset:0
    ds_read_b64_tr_b16 v[52:53], v208 offset:512
    ds_read_b64_tr_b16 v[54:55], v208 offset:8
    ds_read_b64_tr_b16 v[56:57], v208 offset:520
    ds_read_b64_tr_b16 v[58:59], v208 offset:4096
    ds_read_b64_tr_b16 v[60:61], v208 offset:4608
    ds_read_b64_tr_b16 v[62:63], v208 offset:4104
    ds_read_b64_tr_b16 v[64:65], v208 offset:4616
    s_waitcnt lgkmcnt(15)
    s_waitcnt lgkmcnt(12)
    s_mov_b32 s45, 0x3e8293ee
    v_lshlrev_b32 v214, 16, v2
    v_and_b32 v215, 0xffff0000, v2
    v_mul_f32 v214, s45, v214
    v_mul_f32 v215, s45, v215
    v_cvt_pk_bf16_f32 v2, v214, v215
    v_lshlrev_b32 v214, 16, v3
    v_and_b32 v215, 0xffff0000, v3
    v_mul_f32 v214, s45, v214
    v_mul_f32 v215, s45, v215
    v_cvt_pk_bf16_f32 v3, v214, v215
    v_lshlrev_b32 v214, 16, v4
    v_and_b32 v215, 0xffff0000, v4
    v_mul_f32 v214, s45, v214
    v_mul_f32 v215, s45, v215
    v_cvt_pk_bf16_f32 v4, v214, v215
    v_lshlrev_b32 v214, 16, v5
    v_and_b32 v215, 0xffff0000, v5
    v_mul_f32 v214, s45, v214
    v_mul_f32 v215, s45, v215
    v_cvt_pk_bf16_f32 v5, v214, v215
    v_lshlrev_b32 v214, 16, v6
    v_and_b32 v215, 0xffff0000, v6
    v_mul_f32 v214, s45, v214
    v_mul_f32 v215, s45, v215
    v_cvt_pk_bf16_f32 v6, v214, v215
    v_lshlrev_b32 v214, 16, v7
    v_and_b32 v215, 0xffff0000, v7
    v_mul_f32 v214, s45, v214
    v_mul_f32 v215, s45, v215
    v_cvt_pk_bf16_f32 v7, v214, v215
    v_lshlrev_b32 v214, 16, v8
    v_and_b32 v215, 0xffff0000, v8
    v_mul_f32 v214, s45, v214
    v_mul_f32 v215, s45, v215
    v_cvt_pk_bf16_f32 v8, v214, v215
    v_lshlrev_b32 v214, 16, v9
    v_and_b32 v215, 0xffff0000, v9
    v_mul_f32 v214, s45, v214
    v_mul_f32 v215, s45, v215
    v_cvt_pk_bf16_f32 v9, v214, v215
    v_lshlrev_b32 v214, 16, v10
    v_and_b32 v215, 0xffff0000, v10
    v_mul_f32 v214, s45, v214
    v_mul_f32 v215, s45, v215
    v_cvt_pk_bf16_f32 v10, v214, v215
    v_lshlrev_b32 v214, 16, v11
    v_and_b32 v215, 0xffff0000, v11
    v_mul_f32 v214, s45, v214
    v_mul_f32 v215, s45, v215
    v_cvt_pk_bf16_f32 v11, v214, v215
    v_lshlrev_b32 v214, 16, v12
    v_and_b32 v215, 0xffff0000, v12
    v_mul_f32 v214, s45, v214
    v_mul_f32 v215, s45, v215
    v_cvt_pk_bf16_f32 v12, v214, v215
    v_lshlrev_b32 v214, 16, v13
    v_and_b32 v215, 0xffff0000, v13
    v_mul_f32 v214, s45, v214
    v_mul_f32 v215, s45, v215
    v_cvt_pk_bf16_f32 v13, v214, v215
    v_lshlrev_b32 v214, 16, v14
    v_and_b32 v215, 0xffff0000, v14
    v_mul_f32 v214, s45, v214
    v_mul_f32 v215, s45, v215
    v_cvt_pk_bf16_f32 v14, v214, v215
    v_lshlrev_b32 v214, 16, v15
    v_and_b32 v215, 0xffff0000, v15
    v_mul_f32 v214, s45, v214
    v_mul_f32 v215, s45, v215
    v_cvt_pk_bf16_f32 v15, v214, v215
    v_lshlrev_b32 v214, 16, v16
    v_and_b32 v215, 0xffff0000, v16
    v_mul_f32 v214, s45, v214
    v_mul_f32 v215, s45, v215
    v_cvt_pk_bf16_f32 v16, v214, v215
    v_lshlrev_b32 v214, 16, v17
    v_and_b32 v215, 0xffff0000, v17
    v_mul_f32 v214, s45, v214
    v_mul_f32 v215, s45, v215
    v_cvt_pk_bf16_f32 v17, v214, v215
    s_mov_b32 s48, 0x19800000
    s_mov_b32 s49, 0x3f800000
    s_waitcnt vmcnt(6) lgkmcnt(0)
    s_barrier
    ds_read_b128 v[134:137], v246 offset:0
    ds_read_b128 v[138:141], v247 offset:0
    ds_read_b128 v[142:145], v246 offset:2048
    ds_read_b128 v[146:149], v247 offset:2048
    s_waitcnt lgkmcnt(2)
    v_mfma_f32_16x16x32_bf16 v[150:153], v[2:5], v[134:137], 0
    s_waitcnt lgkmcnt(0)
    v_mfma_f32_16x16x32_bf16 v[154:157], v[6:9], v[134:137], 0
    v_mfma_f32_16x16x32_bf16 v[158:161], v[18:21], v[134:137], 0
    v_mfma_f32_16x16x32_bf16 v[162:165], v[22:25], v[134:137], 0
    v_mfma_f32_16x16x32_bf16 v[150:153], v[10:13], v[138:141], v[150:153]
    v_mfma_f32_16x16x32_bf16 v[154:157], v[14:17], v[138:141], v[154:157]
    v_mfma_f32_16x16x32_bf16 v[158:161], v[26:29], v[138:141], v[158:161]
    v_mfma_f32_16x16x32_bf16 v[162:165], v[30:33], v[138:141], v[162:165]
    s_nop 4
    v_cvt_pk_bf16_f32 v166, v150, v151
    v_cvt_pk_bf16_f32 v167, v152, v153
    v_mfma_f32_16x16x32_bf16 v[150:153], v[134:137], v[34:37], 0
    v_cvt_pk_bf16_f32 v168, v154, v155
    v_cvt_pk_bf16_f32 v169, v156, v157
    v_mfma_f32_16x16x32_bf16 v[150:153], v[138:141], v[42:45], v[150:153]
    v_cvt_pk_bf16_f32 v66, v158, v159
    v_cvt_pk_bf16_f32 v67, v160, v161
    v_mfma_f32_16x16x32_bf16 v[154:157], v[134:137], v[38:41], 0
    v_cvt_pk_bf16_f32 v68, v162, v163
    v_cvt_pk_bf16_f32 v69, v164, v165
    v_mfma_f32_16x16x32_bf16 v[154:157], v[138:141], v[46:49], v[154:157]
    s_waitcnt vmcnt(4)
    s_barrier
    ds_read_b128 v[134:137], v246 offset:4096
    v_mfma_f32_16x16x32_bf16 v[178:181], v[66:69], v[166:169], v[242:245]
    ds_read_b128 v[138:141], v247 offset:4096
    v_cvt_pk_bf16_f32 v94, v150, v151
    v_cvt_pk_bf16_f32 v95, v152, v153
    v_mfma_f32_16x16x32_bf16 v[158:161], v[2:5], v[142:145], 0
    s_nop 0
    v_cvt_pk_bf16_f32 v108, v154, v155
    v_cvt_pk_bf16_f32 v109, v156, v157
    v_mfma_f32_16x16x32_bf16 v[158:161], v[10:13], v[146:149], v[158:161]
    v_exp_f32 v180, v180
    v_mfma_f32_16x16x32_bf16 v[162:165], v[6:9], v[142:145], 0
    v_exp_f32 v181, v181
    v_mfma_f32_16x16x32_bf16 v[162:165], v[14:17], v[146:149], v[162:165]
    v_exp_f32 v178, v178
    v_mfma_f32_16x16x32_bf16 v[150:153], v[18:21], v[142:145], 0
    v_exp_f32 v179, v179
    v_mfma_f32_16x16x32_bf16 v[150:153], v[26:29], v[146:149], v[150:153]
    v_cvt_pk_bf16_f32 v170, v158, v159
    v_cvt_pk_bf16_f32 v171, v160, v161
    v_mfma_f32_16x16x32_bf16 v[154:157], v[22:25], v[142:145], 0
    s_nop 0
    v_cvt_pk_bf16_f32 v172, v162, v163
    v_cvt_pk_bf16_f32 v173, v164, v165
    v_mfma_f32_16x16x32_bf16 v[154:157], v[30:33], v[146:149], v[154:157]
    s_nop 0
    v_cvt_pk_bf16_f32 v70, v150, v151
    v_cvt_pk_bf16_f32 v71, v152, v153
    v_mfma_f32_16x16x32_bf16 v[186:189], v[66:69], v[170:173], v[242:245]
    v_cvt_pk_bf16_f32 v181, v180, v181
    v_cvt_pk_bf16_f32 v180, v178, v179
    v_mfma_f32_16x16x32_bf16 v[158:161], v[142:145], v[34:37], 0
    s_waitcnt lgkmcnt(0)
    v_cvt_pk_bf16_f32 v72, v154, v155
    v_cvt_pk_bf16_f32 v73, v156, v157
    v_mfma_f32_16x16x32_bf16 v[158:161], v[146:149], v[42:45], v[158:161]
    s_nop 0
    v_exp_f32 v188, v188
    v_mfma_f32_16x16x32_bf16 v[190:193], v[70:73], v[170:173], v[242:245]
    v_exp_f32 v189, v189
    v_mfma_f32_16x16x32_bf16 v[182:185], v[70:73], v[166:169], v[242:245]
    v_exp_f32 v186, v186
    v_mfma_f32_16x16x32_bf16 v[162:165], v[142:145], v[38:41], 0
    s_nop 0
    v_cvt_pk_bf16_f32 v96, v158, v159
    v_cvt_pk_bf16_f32 v97, v160, v161
    v_mfma_f32_16x16x32_bf16 v[162:165], v[146:149], v[46:49], v[162:165]
    ds_read_b128 v[142:145], v246 offset:6144
    ds_read_b128 v[146:149], v247 offset:6144
    v_cvt_pk_bf16_f32 v189, v188, v189
    v_mfma_f32_16x16x32_bf16 v[150:153], v[18:21], v[134:137], 0
    v_exp_f32 v190, v190
    v_mfma_f32_16x16x32_bf16 v[154:157], v[22:25], v[134:137], 0
    v_exp_f32 v191, v191
    v_mfma_f32_16x16x32_bf16 v[158:161], v[134:137], v[34:37], 0
    v_cvt_pk_bf16_f32 v110, v162, v163
    v_cvt_pk_bf16_f32 v111, v164, v165
    v_mfma_f32_16x16x32_bf16 v[150:153], v[26:29], v[138:141], v[150:153]
    v_exp_f32 v187, v187
    v_mfma_f32_16x16x32_bf16 v[162:165], v[134:137], v[38:41], 0
    v_exp_f32 v192, v192
    v_mfma_f32_16x16x32_bf16 v[154:157], v[30:33], v[138:141], v[154:157]
    s_waitcnt vmcnt(2)
    s_barrier
    ds_read_b128 v[134:137], v246 offset:8192
    v_mfma_f32_16x16x32_bf16 v[158:161], v[138:141], v[42:45], v[158:161]
    s_nop 0
    v_cvt_pk_bf16_f32 v74, v150, v151
    v_cvt_pk_bf16_f32 v75, v152, v153
    v_mfma_f32_16x16x32_bf16 v[162:165], v[138:141], v[46:49], v[162:165]
    s_nop 0
    v_cvt_pk_bf16_f32 v76, v154, v155
    v_cvt_pk_bf16_f32 v77, v156, v157
    ds_read_b128 v[138:141], v247 offset:8192
    v_cvt_pk_bf16_f32 v98, v158, v159
    v_mfma_f32_16x16x32_bf16 v[194:197], v[74:77], v[166:169], v[242:245]
    v_cvt_pk_bf16_f32 v99, v160, v161
    v_cvt_pk_bf16_f32 v190, v190, v191
    s_waitcnt lgkmcnt(2)
    v_mfma_f32_16x16x32_bf16 v[150:153], v[18:21], v[142:145], 0
    v_cvt_pk_bf16_f32 v112, v162, v163
    v_cvt_pk_bf16_f32 v113, v164, v165
    v_mfma_f32_16x16x32_bf16 v[154:157], v[22:25], v[142:145], 0
    v_exp_f32 v193, v193
    v_mfma_f32_16x16x32_bf16 v[158:161], v[142:145], v[34:37], 0
    v_cvt_pk_bf16_f32 v188, v186, v187
    v_cvt_pk_bf16_f32 v191, v192, v193
    v_mfma_f32_16x16x32_bf16 v[162:165], v[142:145], v[38:41], 0
    v_exp_f32 v182, v182
    v_mfma_f32_16x16x32_bf16 v[150:153], v[26:29], v[146:149], v[150:153]
    ds_read_b128 v[142:145], v246 offset:10240
    v_exp_f32 v183, v183
    v_mfma_f32_16x16x32_bf16 v[154:157], v[30:33], v[146:149], v[154:157]
    v_exp_f32 v184, v184
    v_mfma_f32_16x16x32_bf16 v[158:161], v[146:149], v[42:45], v[158:161]
    v_exp_f32 v185, v185
    v_mfma_f32_16x16x32_bf16 v[162:165], v[146:149], v[46:49], v[162:165]
    s_nop 0
    v_cvt_pk_bf16_f32 v78, v150, v151
    v_cvt_pk_bf16_f32 v79, v152, v153
    v_mfma_f32_16x16x32_bf16 v[234:237], v[238:241], v[188:191], 0
    ds_read_b128 v[146:149], v247 offset:10240
    v_cvt_pk_bf16_f32 v80, v154, v155
    v_cvt_pk_bf16_f32 v100, v158, v159
    v_mfma_f32_16x16x32_bf16 v[214:217], v[94:97], v[188:191], 0
    s_waitcnt lgkmcnt(2)
    v_cvt_pk_bf16_f32 v114, v162, v163
    v_cvt_pk_bf16_f32 v115, v164, v165
    v_mfma_f32_16x16x32_bf16 v[162:165], v[134:137], v[38:41], 0
    v_cvt_pk_bf16_f32 v101, v160, v161
    v_cvt_pk_bf16_f32 v81, v156, v157
    v_mfma_f32_16x16x32_bf16 v[162:165], v[138:141], v[46:49], v[162:165]
    v_cvt_pk_bf16_f32 v182, v182, v183
    v_cvt_pk_bf16_f32 v183, v184, v185
    v_mfma_f32_16x16x32_bf16 v[198:201], v[78:81], v[166:169], v[242:245]
    v_exp_f32 v196, v196
    v_mfma_f32_16x16x32_bf16 v[158:161], v[134:137], v[34:37], 0
    v_exp_f32 v197, v197
    v_mfma_f32_16x16x32_bf16 v[158:161], v[138:141], v[42:45], v[158:161]
    s_nop 0
    v_cvt_pk_bf16_f32 v116, v162, v163
    v_cvt_pk_bf16_f32 v117, v164, v165
    v_mfma_f32_16x16x32_bf16 v[230:233], v[238:241], v[180:183], 0
    v_exp_f32 v198, v198
    v_mfma_f32_16x16x32_bf16 v[150:153], v[18:21], v[134:137], 0
    v_exp_f32 v199, v199
    v_mfma_f32_16x16x32_bf16 v[150:153], v[26:29], v[138:141], v[150:153]
    v_cvt_pk_bf16_f32 v102, v158, v159
    v_cvt_pk_bf16_f32 v103, v160, v161
    v_mfma_f32_16x16x32_bf16 v[154:157], v[22:25], v[134:137], 0
    s_waitcnt lgkmcnt(0)
    ds_read_b128 v[134:137], v246 offset:4096
    v_cvt_pk_bf16_f32 v197, v196, v197
    v_mfma_f32_16x16x32_bf16 v[154:157], v[30:33], v[138:141], v[154:157]
    s_nop 0
    v_cvt_pk_bf16_f32 v82, v150, v151
    v_cvt_pk_bf16_f32 v83, v152, v153
    v_mfma_f32_16x16x32_bf16 v[162:165], v[142:145], v[38:41], 0
    ds_read_b128 v[138:141], v247 offset:4096
    v_exp_f32 v194, v194
    v_mfma_f32_16x16x32_bf16 v[162:165], v[146:149], v[46:49], v[162:165]
    s_nop 0
    v_cvt_pk_bf16_f32 v84, v154, v155
    v_cvt_pk_bf16_f32 v85, v156, v157
    v_mfma_f32_16x16x32_bf16 v[158:161], v[142:145], v[34:37], 0
    v_exp_f32 v195, v195
    v_mfma_f32_16x16x32_bf16 v[158:161], v[146:149], v[42:45], v[158:161]
    v_exp_f32 v200, v200
    v_mfma_f32_16x16x32_bf16 v[150:153], v[18:21], v[142:145], 0
    v_cvt_pk_bf16_f32 v119, v164, v165
    v_cvt_pk_bf16_f32 v118, v162, v163
    v_mfma_f32_16x16x32_bf16 v[150:153], v[26:29], v[146:149], v[150:153]
    s_waitcnt vmcnt(0)
    v_exp_f32 v201, v201
    v_mfma_f32_16x16x32_bf16 v[126:129], v[50:53], v[222:225], 0
    v_cvt_pk_bf16_f32 v104, v158, v159
    v_cvt_pk_bf16_f32 v105, v160, v161
    v_mfma_f32_16x16x32_bf16 v[126:129], v[58:61], v[226:229], v[126:129]
    v_cvt_pk_bf16_f32 v198, v198, v199
    v_cvt_pk_bf16_f32 v196, v194, v195
    v_mfma_f32_16x16x32_bf16 v[130:133], v[54:57], v[222:225], 0
    v_cvt_pk_bf16_f32 v86, v150, v151
    v_cvt_pk_bf16_f32 v87, v152, v153
    v_mfma_f32_16x16x32_bf16 v[130:133], v[62:65], v[226:229], v[130:133]
    v_cvt_pk_bf16_f32 v199, v200, v201
    v_mfma_f32_16x16x32_bf16 v[154:157], v[22:25], v[142:145], 0
    s_waitcnt lgkmcnt(0)
    ds_read_b128 v[142:145], v246 offset:6144
    v_mfma_f32_16x16x32_bf16 v[154:157], v[30:33], v[146:149], v[154:157]
    ds_read_b128 v[146:149], v247 offset:6144
    v_mfma_f32_16x16x32_bf16 v[158:161], v[222:225], v[34:37], 0
    v_mfma_f32_16x16x32_bf16 v[162:165], v[222:225], v[38:41], 0
    v_mfma_f32_16x16x32_bf16 v[158:161], v[226:229], v[42:45], v[158:161]
    v_mfma_f32_16x16x32_bf16 v[162:165], v[226:229], v[46:49], v[162:165]
    v_mfma_f32_16x16x32_bf16 v[150:153], v[18:21], v[222:225], 0
    s_nop 1
    v_cvt_pk_bf16_f32 v88, v154, v155
    v_mfma_f32_16x16x32_bf16 v[230:233], v[238:241], v[196:199], v[230:233]
    v_cvt_pk_bf16_f32 v89, v156, v157
    s_nop 0
    v_cvt_pk_bf16_f32 v106, v158, v159
    v_mfma_f32_16x16x32_bf16 v[150:153], v[26:29], v[226:229], v[150:153]
    v_cvt_pk_bf16_f32 v107, v160, v161
    v_cvt_pk_bf16_f32 v120, v162, v163
    v_mfma_f32_16x16x32_bf16 v[158:161], v[2:5], v[134:137], 0
    v_cvt_pk_bf16_f32 v121, v164, v165
    v_mfma_f32_16x16x32_bf16 v[162:165], v[6:9], v[134:137], 0
    ds_read_b128 v[134:137], v246 offset:0
    v_mfma_f32_16x16x32_bf16 v[158:161], v[10:13], v[138:141], v[158:161]
    s_waitcnt lgkmcnt(1)
    v_cvt_pk_bf16_f32 v90, v150, v151
    v_cvt_pk_bf16_f32 v91, v152, v153
    v_mfma_f32_16x16x32_bf16 v[162:165], v[14:17], v[138:141], v[162:165]
    ds_read_b128 v[138:141], v247 offset:0
    v_mfma_f32_16x16x32_bf16 v[154:157], v[22:25], v[222:225], 0
    s_nop 1
    v_cvt_pk_bf16_f32 v174, v158, v159
    v_mfma_f32_16x16x32_bf16 v[154:157], v[30:33], v[226:229], v[154:157]
    v_cvt_pk_bf16_f32 v175, v160, v161
    v_mfma_f32_16x16x32_bf16 v[150:153], v[2:5], v[222:225], 0
    v_cvt_pk_bf16_f32 v176, v162, v163
    v_cvt_pk_bf16_f32 v177, v164, v165
    v_mfma_f32_16x16x32_bf16 v[150:153], v[10:13], v[226:229], v[150:153]
    v_mfma_f32_16x16x32_bf16 v[218:221], v[108:111], v[188:191], 0
    s_nop 1
    v_cvt_pk_bf16_f32 v92, v154, v155
    v_mfma_f32_16x16x32_bf16 v[186:189], v[82:85], v[166:169], v[242:245]
    v_cvt_pk_bf16_f32 v93, v156, v157
    v_mfma_f32_16x16x32_bf16 v[190:193], v[86:89], v[166:169], v[242:245]
    s_nop 0
    v_cvt_pk_bf16_f32 v122, v150, v151
    v_cvt_pk_bf16_f32 v123, v152, v153
    v_mfma_f32_16x16x32_bf16 v[158:161], v[2:5], v[142:145], 0
    s_nop 1
    v_exp_f32 v188, v188
    v_mfma_f32_16x16x32_bf16 v[158:161], v[10:13], v[146:149], v[158:161]
    v_exp_f32 v189, v189
    v_mfma_f32_16x16x32_bf16 v[150:153], v[90:93], v[166:169], v[242:245]
    s_waitcnt lgkmcnt(0)
    v_exp_f32 v190, v190
    v_mfma_f32_16x16x32_bf16 v[162:165], v[6:9], v[142:145], 0
    v_exp_f32 v191, v191
    v_mfma_f32_16x16x32_bf16 v[162:165], v[14:17], v[146:149], v[162:165]
    ds_read_b128 v[142:145], v246 offset:2048
    v_exp_f32 v186, v186
    v_mfma_f32_16x16x32_bf16 v[206:209], v[94:97], v[180:183], 0
    ds_read_b128 v[146:149], v247 offset:2048
    v_exp_f32 v187, v187
    v_mfma_f32_16x16x32_bf16 v[206:209], v[98:101], v[196:199], v[206:209]
    v_exp_f32 v192, v192
    v_mfma_f32_16x16x32_bf16 v[154:157], v[6:9], v[222:225], 0
    v_exp_f32 v193, v193
    v_mfma_f32_16x16x32_bf16 v[222:225], v[50:53], v[134:137], 0
    v_cvt_pk_bf16_f32 v189, v188, v189
    v_cvt_pk_bf16_f32 v190, v190, v191
    v_mfma_f32_16x16x32_bf16 v[222:225], v[58:61], v[138:141], v[222:225]
    v_cvt_pk_bf16_f32 v188, v186, v187
    v_cvt_pk_bf16_f32 v191, v192, v193
    v_mfma_f32_16x16x32_bf16 v[154:157], v[14:17], v[226:229], v[154:157]
    v_exp_f32 v150, v150
    v_mfma_f32_16x16x32_bf16 v[230:233], v[238:241], v[188:191], v[230:233]
    v_cvt_pk_bf16_f32 v202, v150, 0
    v_cvt_pk_bf16_f32 v166, v158, v159
    v_mfma_f32_16x16x32_bf16 v[206:209], v[102:105], v[188:191], v[206:209]
    s_add_u32 m0, s55, 12288
    v_cvt_pk_bf16_f32 v167, v160, v161
    v_cvt_pk_bf16_f32 v168, v162, v163
    v_mfma_f32_16x16x32_bf16 v[226:229], v[54:57], v[134:137], 0
    s_add_u32 s36, s33, 13107200
    v_cvt_pk_bf16_f32 v124, v154, v155
    v_cvt_pk_bf16_f32 v125, v156, v157
    v_mfma_f32_16x16x16_bf16 v[230:233], v[238:239], v[202:203], v[230:233]
    v_cvt_pk_bf16_f32 v169, v164, v165
    buffer_load_dwordx4 v248, s[8:11], s36 offen nt lds
    buffer_load_dwordx4 v248, s[8:11], s36 offen offset:2048 nt lds
    v_mfma_f32_16x16x16_bf16 v[206:209], v[106:107], v[202:203], v[206:209]
    s_waitcnt lgkmcnt(0)
    v_mfma_f32_16x16x32_bf16 v[210:213], v[108:111], v[180:183], 0
    ds_read_b128 v[134:137], v246 offset:4096
    s_nop 0
    v_rcp_f32 v231, v230
    v_mfma_f32_16x16x32_bf16 v[178:181], v[74:77], v[170:173], v[242:245]
    s_nop 1
    v_fma_f32 v206, v206, v231, v222
    v_mfma_f32_16x16x32_bf16 v[182:185], v[78:81], v[170:173], v[242:245]
    v_fma_f32 v207, v207, v231, v223
    v_fma_f32 v208, v208, v231, v224
    v_mfma_f32_16x16x32_bf16 v[210:213], v[112:115], v[196:199], v[210:213]
    s_nop 0
    v_exp_f32 v180, v180
    v_mfma_f32_16x16x32_bf16 v[194:197], v[82:85], v[170:173], v[242:245]
    v_exp_f32 v181, v181
    v_mfma_f32_16x16x32_bf16 v[198:201], v[86:89], v[170:173], v[242:245]
    v_exp_f32 v182, v182
    v_mfma_f32_16x16x32_bf16 v[210:213], v[116:119], v[188:191], v[210:213]
    v_exp_f32 v183, v183
    v_mfma_f32_16x16x32_bf16 v[154:157], v[90:93], v[170:173], v[242:245]
    v_exp_f32 v178, v178
    v_mfma_f32_16x16x32_bf16 v[226:229], v[62:65], v[138:141], v[226:229]
    v_exp_f32 v179, v179
    v_mfma_f32_16x16x32_bf16 v[186:189], v[74:77], v[174:177], v[242:245]
    ds_read_b128 v[138:141], v247 offset:4096
    v_exp_f32 v184, v184
    v_mfma_f32_16x16x16_bf16 v[210:213], v[120:121], v[202:203], v[210:213]
    v_exp_f32 v185, v185
    v_cvt_pk_bf16_f32 v181, v180, v181
    v_mfma_f32_16x16x32_bf16 v[190:193], v[78:81], v[174:177], v[242:245]
    v_cvt_pk_bf16_f32 v182, v182, v183
    v_cvt_pk_bf16_f32 v180, v178, v179
    v_cvt_pk_bf16_f32 v183, v184, v185
    v_exp_f32 v196, v196
    v_exp_f32 v197, v197
    v_mfma_f32_16x16x32_bf16 v[234:237], v[238:241], v[180:183], v[234:237]
    v_exp_f32 v198, v198
    v_mfma_f32_16x16x32_bf16 v[214:217], v[98:101], v[180:183], v[214:217]
    v_exp_f32 v199, v199
    v_mfma_f32_16x16x32_bf16 v[218:221], v[112:115], v[180:183], v[218:221]
    v_exp_f32 v194, v194
    v_mfma_f32_16x16x32_bf16 v[178:181], v[66:69], v[174:177], v[242:245]
    v_exp_f32 v195, v195
    v_mfma_f32_16x16x32_bf16 v[182:185], v[70:73], v[174:177], v[242:245]
    v_exp_f32 v200, v200
    v_exp_f32 v201, v201
    v_cvt_pk_bf16_f32 v197, v196, v197
    v_cvt_pk_bf16_f32 v198, v198, v199
    s_waitcnt lgkmcnt(0)
    v_cvt_pk_bf16_f32 v196, v194, v195
    v_cvt_pk_bf16_f32 v199, v200, v201
    v_exp_f32 v154, v154
    v_fma_f32 v209, v209, v231, v225
    v_mfma_f32_16x16x32_bf16 v[234:237], v[238:241], v[196:199], v[234:237]
    v_cvt_pk_bf16_f32 v204, v154, 0
    v_fma_f32 v210, v210, v231, v226
    v_mfma_f32_16x16x32_bf16 v[214:217], v[102:105], v[196:199], v[214:217]
    s_add_u32 m0, s55, 16384
    v_fma_f32 v211, v211, v231, v227
    v_fma_f32 v212, v212, v231, v228
    v_mfma_f32_16x16x32_bf16 v[218:221], v[116:119], v[196:199], v[218:221]
    s_add_u32 s37, s33, 13111296
    v_fma_f32 v213, v213, v231, v229
    v_cvt_pk_bf16_f32 v206, v206, v207
    v_mfma_f32_16x16x32_bf16 v[222:225], v[50:53], v[142:145], 0
    buffer_load_dwordx4 v248, s[8:11], s37 offen nt lds
    v_cvt_pk_bf16_f32 v207, v208, v209
    v_cvt_pk_bf16_f32 v208, v210, v211
    v_mfma_f32_16x16x16_bf16 v[234:237], v[238:239], v[204:205], v[234:237]
    v_cvt_pk_bf16_f32 v209, v212, v213
    v_pk_max_i16 v206, v206, 0
    v_pk_max_i16 v207, v207, 0
    v_mfma_f32_16x16x32_bf16 v[226:229], v[54:57], v[142:145], 0
    buffer_load_dwordx4 v248, s[8:11], s37 offen offset:2048 nt lds
    v_pk_max_i16 v208, v208, 0
    v_pk_max_i16 v209, v209, 0
    v_mfma_f32_16x16x32_bf16 v[222:225], v[58:61], v[146:149], v[222:225]
    ds_write_b128 v252, v[206:209] offset:32768
    v_rcp_f32 v235, v234
    v_mfma_f32_16x16x16_bf16 v[214:217], v[106:107], v[204:205], v[214:217]
    v_exp_f32 v180, v180
    v_exp_f32 v181, v181
    v_mfma_f32_16x16x32_bf16 v[226:229], v[62:65], v[146:149], v[226:229]
    ds_read_b128 v[142:145], v246 offset:8192
    v_exp_f32 v182, v182
    v_mfma_f32_16x16x16_bf16 v[218:221], v[120:121], v[204:205], v[218:221]
    v_exp_f32 v183, v183
    v_cvt_pk_bf16_f32 v181, v180, v181
    v_mfma_f32_16x16x32_bf16 v[194:197], v[82:85], v[174:177], v[242:245]
    ds_read_b128 v[146:149], v247 offset:8192
    v_fma_f32 v214, v214, v235, v222
    v_fma_f32 v215, v215, v235, v223
    v_mfma_f32_16x16x32_bf16 v[198:201], v[86:89], v[174:177], v[242:245]
    s_add_u32 m0, s55, 20480
    v_fma_f32 v216, v216, v235, v224
    v_fma_f32 v217, v217, v235, v225
    v_mfma_f32_16x16x32_bf16 v[222:225], v[50:53], v[134:137], 0
    s_add_u32 s38, s33, 13115392
    v_cvt_pk_bf16_f32 v214, v214, v215
    v_fma_f32 v218, v218, v235, v226
    v_mfma_f32_16x16x32_bf16 v[222:225], v[58:61], v[138:141], v[222:225]
    buffer_load_dwordx4 v248, s[8:11], s38 offen nt lds
    v_fma_f32 v219, v219, v235, v227
    v_fma_f32 v220, v220, v235, v228
    v_fma_f32 v221, v221, v235, v229
    v_mfma_f32_16x16x32_bf16 v[226:229], v[54:57], v[134:137], 0
    buffer_load_dwordx4 v248, s[8:11], s38 offen offset:2048 nt lds
    v_cvt_pk_bf16_f32 v215, v216, v217
    v_cvt_pk_bf16_f32 v216, v218, v219
    v_mfma_f32_16x16x32_bf16 v[226:229], v[62:65], v[138:141], v[226:229]
    s_add_u32 s39, s33, 0
    v_cvt_pk_bf16_f32 v217, v220, v221
    v_pk_max_i16 v214, v214, 0
    ds_read_b128 v[134:137], v246 offset:6144
    ds_read_b128 v[138:141], v247 offset:6144
    v_pk_max_i16 v215, v215, 0
    v_pk_max_i16 v216, v216, 0
    v_pk_max_i16 v217, v217, 0
    ds_write_b128 v252, v[214:217] offset:34816
    v_exp_f32 v178, v178
    v_exp_f32 v179, v179
    v_exp_f32 v184, v184
    v_exp_f32 v185, v185
    v_cvt_pk_bf16_f32 v182, v182, v183
    v_cvt_pk_bf16_f32 v180, v178, v179
    s_waitcnt lgkmcnt(3)
    v_mfma_f32_16x16x32_bf16 v[158:161], v[2:5], v[142:145], 0
    s_add_u32 s40, s33, 2048
    v_cvt_pk_bf16_f32 v183, v184, v185
    v_max3_u32 v0, v0, v230, v234
    v_mfma_f32_16x16x32_bf16 v[162:165], v[6:9], v[142:145], 0
    v_exp_f32 v188, v188
    v_mfma_f32_16x16x32_bf16 v[158:161], v[10:13], v[146:149], v[158:161]
    ds_read_b128 v[142:145], v246 offset:10240
    v_exp_f32 v189, v189
    v_mfma_f32_16x16x32_bf16 v[162:165], v[14:17], v[146:149], v[162:165]
    v_exp_f32 v190, v190
    v_mfma_f32_16x16x32_bf16 v[206:209], v[94:97], v[180:183], 0
    ds_read_b128 v[146:149], v247 offset:10240
    v_exp_f32 v191, v191
    v_mfma_f32_16x16x32_bf16 v[210:213], v[108:111], v[180:183], 0
    v_min3_u32 v1, v1, v230, v234
    v_cvt_pk_bf16_f32 v189, v188, v189
    v_mfma_f32_16x16x32_bf16 v[230:233], v[238:241], v[180:183], 0
    s_waitcnt lgkmcnt(3)
    v_exp_f32 v186, v186
    v_mfma_f32_16x16x32_bf16 v[178:181], v[66:69], v[166:169], v[242:245]
    v_exp_f32 v187, v187
    v_mfma_f32_16x16x32_bf16 v[182:185], v[70:73], v[166:169], v[242:245]
    v_exp_f32 v192, v192
    v_exp_f32 v193, v193
    v_cvt_pk_bf16_f32 v190, v190, v191
    v_cvt_pk_bf16_f32 v188, v186, v187
    v_cvt_pk_bf16_f32 v191, v192, v193
    v_exp_f32 v196, v196
    v_exp_f32 v197, v197
    v_mfma_f32_16x16x32_bf16 v[230:233], v[238:241], v[188:191], v[230:233]
    s_waitcnt lgkmcnt(2)
    s_barrier
    v_exp_f32 v198, v198
    v_mfma_f32_16x16x32_bf16 v[206:209], v[98:101], v[188:191], v[206:209]
    ds_read_b128 v[150:153], v253 offset:32768
    v_exp_f32 v199, v199
    v_mfma_f32_16x16x32_bf16 v[210:213], v[112:115], v[188:191], v[210:213]
    ds_read_b128 v[154:157], v253 offset:34816
    v_exp_f32 v194, v194
    v_mfma_f32_16x16x32_bf16 v[186:189], v[74:77], v[166:169], v[242:245]
    s_waitcnt lgkmcnt(2)
    v_exp_f32 v195, v195
    v_mfma_f32_16x16x32_bf16 v[190:193], v[78:81], v[166:169], v[242:245]
    v_exp_f32 v200, v200
    v_exp_f32 v201, v201
    v_cvt_pk_bf16_f32 v197, v196, v197
    v_cvt_pk_bf16_f32 v198, v198, v199
    v_cvt_pk_bf16_f32 v170, v158, v159
    v_cvt_pk_bf16_f32 v171, v160, v161
    v_mfma_f32_16x16x32_bf16 v[158:161], v[122:125], v[70:73], v[242:245]
    v_cvt_pk_bf16_f32 v196, v194, v195
    v_cvt_pk_bf16_f32 v199, v200, v201
    v_cvt_pk_bf16_f32 v172, v162, v163
    v_cvt_pk_bf16_f32 v173, v164, v165
    v_mfma_f32_16x16x32_bf16 v[162:165], v[122:125], v[74:77], v[242:245]
    v_exp_f32 v180, v180
    v_mfma_f32_16x16x32_bf16 v[230:233], v[238:241], v[196:199], v[230:233]
    v_exp_f32 v181, v181
    v_mfma_f32_16x16x32_bf16 v[206:209], v[102:105], v[196:199], v[206:209]
    v_exp_f32 v182, v182
    v_mfma_f32_16x16x32_bf16 v[210:213], v[116:119], v[196:199], v[210:213]
    s_waitcnt lgkmcnt(1)
    buffer_store_dwordx4 v[150:153], v249, s[12:15], s39 offen sc1
    v_exp_f32 v183, v183
    v_exp_f32 v178, v178
    v_mfma_f32_16x16x32_bf16 v[150:153], v[90:93], v[174:177], v[242:245]
    s_waitcnt lgkmcnt(0)
    buffer_store_dwordx4 v[154:157], v249, s[12:15], s40 offen sc1
    v_exp_f32 v179, v179
    v_exp_f32 v184, v184
    v_mfma_f32_16x16x32_bf16 v[154:157], v[122:125], v[66:69], v[242:245]
    s_add_u32 m0, s55, 24576
    v_exp_f32 v185, v185
    v_exp_f32 v195, v158
    v_mfma_f32_16x16x32_bf16 v[158:161], v[122:125], v[86:89], v[242:245]
    s_add_u32 s41, s33, 26214400
    v_exp_f32 v150, v150
    v_cvt_pk_bf16_f32 v181, v180, v181
    v_cvt_pk_bf16_f32 v202, v150, 0
    v_mfma_f32_16x16x32_bf16 v[150:153], v[122:125], v[78:81], v[242:245]
    buffer_load_dwordx4 v248, s[8:11], s41 offen nt lds
    v_exp_f32 v194, v154
    v_mfma_f32_16x16x16_bf16 v[230:233], v[238:239], v[202:203], v[230:233]
    v_cvt_pk_bf16_f32 v182, v182, v183
    v_exp_f32 v196, v162
    v_mfma_f32_16x16x32_bf16 v[154:157], v[122:125], v[82:85], v[242:245]
    buffer_load_dwordx4 v248, s[8:11], s41 offen offset:2048 nt lds
    v_cvt_pk_bf16_f32 v180, v178, v179
    v_cvt_pk_bf16_f32 v183, v184, v185
    v_mfma_f32_16x16x32_bf16 v[162:165], v[122:125], v[90:93], v[242:245]
    v_exp_f32 v197, v150
    v_mfma_f32_16x16x16_bf16 v[206:209], v[106:107], v[202:203], v[206:209]
    v_cvt_pk_bf16_f32 v194, v194, v195
    v_rcp_f32 v231, v230
    v_mfma_f32_16x16x16_bf16 v[210:213], v[120:121], v[202:203], v[210:213]
    v_exp_f32 v198, v154
    v_cvt_pk_bf16_f32 v196, v196, v197
    v_mfma_f32_16x16x32_bf16 v[214:217], v[94:97], v[180:183], 0
    ds_write_b16 v250, v194 offset:0
    v_exp_f32 v199, v158
    v_mfma_f32_16x16x32_bf16 v[218:221], v[108:111], v[180:183], 0
    ds_write_b16_d16_hi v250, v194 offset:32
    v_fma_f32 v206, v206, v231, v222
    v_fma_f32 v207, v207, v231, v223
    v_mfma_f32_16x16x32_bf16 v[234:237], v[238:241], v[180:183], 0
    ds_write_b16 v250, v196 offset:64
    v_fma_f32 v208, v208, v231, v224
    v_fma_f32 v209, v209, v231, v225
    v_mfma_f32_16x16x32_bf16 v[178:181], v[82:85], v[166:169], v[242:245]
    ds_write_b16_d16_hi v250, v196 offset:96
    v_fma_f32 v210, v210, v231, v226
    v_fma_f32 v211, v211, v231, v227
    v_mfma_f32_16x16x32_bf16 v[182:185], v[86:89], v[166:169], v[242:245]
    v_fma_f32 v212, v212, v231, v228
    v_fma_f32 v213, v213, v231, v229
    v_mfma_f32_16x16x32_bf16 v[222:225], v[50:53], v[134:137], 0
    v_exp_f32 v188, v188
    v_mfma_f32_16x16x32_bf16 v[226:229], v[54:57], v[134:137], 0
    v_exp_f32 v189, v189
    v_mfma_f32_16x16x32_bf16 v[150:153], v[2:5], v[142:145], 0
    v_exp_f32 v190, v190
    v_mfma_f32_16x16x32_bf16 v[154:157], v[6:9], v[142:145], 0
    v_exp_f32 v191, v191
    v_mfma_f32_16x16x32_bf16 v[222:225], v[58:61], v[138:141], v[222:225]
    v_exp_f32 v200, v162
    v_mfma_f32_16x16x32_bf16 v[226:229], v[62:65], v[138:141], v[226:229]
    v_exp_f32 v186, v186
    v_mfma_f32_16x16x32_bf16 v[158:161], v[90:93], v[166:169], v[242:245]
    v_exp_f32 v187, v187
    v_mfma_f32_16x16x32_bf16 v[150:153], v[10:13], v[146:149], v[150:153]
    v_exp_f32 v192, v192
    v_mfma_f32_16x16x32_bf16 v[154:157], v[14:17], v[146:149], v[154:157]
    v_exp_f32 v193, v193
    v_mfma_f32_16x16x32_bf16 v[194:197], v[74:77], v[170:173], v[242:245]
    v_cvt_pk_bf16_f32 v198, v198, v199
    v_cvt_pk_bf16_f32 v189, v188, v189
    v_cvt_pk_bf16_f32 v190, v190, v191
    v_cndmask_b32 v200, 0, v200, s[56:57]
    v_cvt_pk_bf16_f32 v188, v186, v187
    v_cvt_pk_bf16_f32 v191, v192, v193
    v_cvt_pk_bf16_f32 v200, v200, 0
    v_exp_f32 v180, v180
    v_mfma_f32_16x16x32_bf16 v[234:237], v[238:241], v[188:191], v[234:237]
    ds_write_b16 v250, v198 offset:128
    v_exp_f32 v181, v181
    v_mfma_f32_16x16x32_bf16 v[214:217], v[98:101], v[188:191], v[214:217]
    ds_write_b16_d16_hi v250, v198 offset:160
    v_exp_f32 v182, v182
    v_mfma_f32_16x16x32_bf16 v[218:221], v[112:115], v[188:191], v[218:221]
    ds_write_b16 v250, v200 offset:192
    v_exp_f32 v183, v183
    v_mfma_f32_16x16x32_bf16 v[186:189], v[66:69], v[170:173], v[242:245]
    ds_read2_b64 v[134:137], v251 offset0:0 offset1:4
    v_exp_f32 v178, v178
    v_mfma_f32_16x16x32_bf16 v[190:193], v[70:73], v[170:173], v[242:245]
    ds_read2_b64 v[138:141], v251 offset0:8 offset1:12
    v_exp_f32 v179, v179
    v_mfma_f32_16x16x32_bf16 v[198:201], v[78:81], v[170:173], v[242:245]
    ds_read2_b64 v[142:145], v251 offset0:16 offset1:20
    v_exp_f32 v184, v184
    ds_read_b64 v[146:147], v251 offset:192
    v_exp_f32 v185, v185
    v_cvt_pk_bf16_f32 v181, v180, v181
    v_cvt_pk_bf16_f32 v182, v182, v183
    v_cvt_pk_bf16_f32 v180, v178, v179
    v_cvt_pk_bf16_f32 v183, v184, v185
    v_exp_f32 v158, v158
    v_cvt_pk_bf16_f32 v206, v206, v207
    v_mfma_f32_16x16x32_bf16 v[234:237], v[238:241], v[180:183], v[234:237]
    v_cvt_pk_bf16_f32 v204, v158, 0
    v_cvt_pk_bf16_f32 v207, v208, v209
    v_mfma_f32_16x16x32_bf16 v[214:217], v[102:105], v[180:183], v[214:217]
    s_add_u32 m0, s55, 28672
    v_cvt_pk_bf16_f32 v208, v210, v211
    v_cvt_pk_bf16_f32 v209, v212, v213
    v_mfma_f32_16x16x32_bf16 v[218:221], v[116:119], v[180:183], v[218:221]
    s_add_u32 s42, s33, 26218496
    v_pk_max_i16 v206, v206, 0
    v_pk_max_i16 v207, v207, 0
    v_mfma_f32_16x16x16_bf16 v[234:237], v[238:239], v[204:205], v[234:237]
    v_pk_max_i16 v208, v208, 0
    v_pk_max_i16 v209, v209, 0
    v_cvt_pk_bf16_f32 v174, v150, v151
    v_mfma_f32_16x16x16_bf16 v[214:217], v[106:107], v[204:205], v[214:217]
    v_cvt_pk_bf16_f32 v175, v152, v153
    ds_write_b128 v252, v[206:209] offset:0
    v_cvt_pk_bf16_f32 v176, v154, v155
    v_mfma_f32_16x16x16_bf16 v[218:221], v[120:121], v[204:205], v[218:221]
    v_rcp_f32 v235, v234
    v_max3_u32 v0, v0, v230, v234
    v_mfma_f32_16x16x32_bf16 v[178:181], v[82:85], v[170:173], v[242:245]
    buffer_load_dwordx4 v248, s[8:11], s42 offen nt lds
    v_fma_f32 v214, v214, v235, v222
    v_fma_f32 v215, v215, v235, v223
    v_mfma_f32_16x16x32_bf16 v[182:185], v[86:89], v[170:173], v[242:245]
    buffer_load_dwordx4 v248, s[8:11], s42 offen offset:2048 nt lds
    v_fma_f32 v216, v216, v235, v224
    v_fma_f32 v217, v217, v235, v225
    s_waitcnt lgkmcnt(1)
    v_mfma_f32_16x16x32_bf16 v[206:209], v[94:97], v[134:137], 0
    s_add_u32 s43, s33, 4096
    v_cvt_pk_bf16_f32 v214, v214, v215
    v_fma_f32 v218, v218, v235, v226
    v_mfma_f32_16x16x32_bf16 v[210:213], v[108:111], v[134:137], 0
    s_add_u32 s36, s33, 6144
    v_fma_f32 v219, v219, v235, v227
    v_fma_f32 v220, v220, v235, v228
    v_mfma_f32_16x16x32_bf16 v[206:209], v[98:101], v[138:141], v[206:209]
    v_fma_f32 v221, v221, v235, v229
    v_cvt_pk_bf16_f32 v215, v216, v217
    v_mfma_f32_16x16x32_bf16 v[210:213], v[112:115], v[138:141], v[210:213]
    v_cvt_pk_bf16_f32 v216, v218, v219
    v_cvt_pk_bf16_f32 v217, v220, v221
    v_mfma_f32_16x16x32_bf16 v[206:209], v[102:105], v[142:145], v[206:209]
    v_pk_max_i16 v214, v214, 0
    v_pk_max_i16 v215, v215, 0
    v_mfma_f32_16x16x32_bf16 v[210:213], v[116:119], v[142:145], v[210:213]
    v_pk_max_i16 v216, v216, 0
    v_pk_max_i16 v217, v217, 0
    v_min3_u32 v1, v1, v230, v234
    v_mfma_f32_16x16x32_bf16 v[230:233], v[238:241], v[134:137], 0
    ds_write_b128 v252, v[214:217] offset:2048
    ds_read_b128 v[134:137], v246 offset:8192
    v_cvt_pk_bf16_f32 v177, v156, v157
    v_mfma_f32_16x16x32_bf16 v[230:233], v[238:241], v[138:141], v[230:233]
    v_exp_f32 v188, v188
    v_mfma_f32_16x16x32_bf16 v[230:233], v[238:241], v[142:145], v[230:233]
    ds_read_b128 v[138:141], v247 offset:8192
    v_exp_f32 v189, v189
    v_mfma_f32_16x16x16_bf16 v[206:209], v[106:107], v[146:147], v[206:209]
    v_exp_f32 v190, v190
    v_cvt_pk_bf16_f32 v189, v188, v189
    v_mfma_f32_16x16x16_bf16 v[210:213], v[120:121], v[146:147], v[210:213]
    v_exp_f32 v191, v191
    v_exp_f32 v186, v186
    v_mfma_f32_16x16x16_bf16 v[230:233], v[238:239], v[146:147], v[230:233]
    v_exp_f32 v187, v187
    v_cvt_pk_bf16_f32 v190, v190, v191
    v_mfma_f32_16x16x32_bf16 v[154:157], v[90:93], v[170:173], v[242:245]
    v_exp_f32 v192, v192
    v_exp_f32 v193, v193
    v_cvt_pk_bf16_f32 v188, v186, v187
    v_cvt_pk_bf16_f32 v191, v192, v193
    v_exp_f32 v196, v196
    v_exp_f32 v197, v197
    v_mfma_f32_16x16x32_bf16 v[214:217], v[94:97], v[188:191], 0
    s_nop 0
    v_exp_f32 v154, v154
    v_mfma_f32_16x16x32_bf16 v[218:221], v[108:111], v[188:191], 0
    v_cvt_pk_bf16_f32 v202, v154, 0
    v_cvt_pk_bf16_f32 v197, v196, v197
    v_mfma_f32_16x16x32_bf16 v[234:237], v[238:241], v[188:191], 0
    v_exp_f32 v198, v198
    v_mfma_f32_16x16x32_bf16 v[186:189], v[66:69], v[174:177], v[242:245]
    s_waitcnt lgkmcnt(0)
    s_barrier
    ds_read_b128 v[162:165], v253 offset:0
    v_mfma_f32_16x16x32_bf16 v[222:225], v[50:53], v[134:137], 0
    ds_read_b128 v[150:153], v253 offset:2048
    v_exp_f32 v199, v199
    v_mfma_f32_16x16x32_bf16 v[226:229], v[54:57], v[134:137], 0
    v_exp_f32 v194, v194
    v_mfma_f32_16x16x32_bf16 v[222:225], v[58:61], v[138:141], v[222:225]
    v_exp_f32 v195, v195
    v_mfma_f32_16x16x32_bf16 v[226:229], v[62:65], v[138:141], v[226:229]
    v_exp_f32 v200, v200
    v_mfma_f32_16x16x32_bf16 v[190:193], v[70:73], v[174:177], v[242:245]
    v_exp_f32 v201, v201
    v_cvt_pk_bf16_f32 v198, v198, v199
    v_cvt_pk_bf16_f32 v196, v194, v195
    v_cvt_pk_bf16_f32 v199, v200, v201
    v_exp_f32 v180, v180
    v_exp_f32 v181, v181
    v_mfma_f32_16x16x32_bf16 v[234:237], v[238:241], v[196:199], v[234:237]
    v_exp_f32 v182, v182
    v_mfma_f32_16x16x32_bf16 v[214:217], v[98:101], v[196:199], v[214:217]
    v_exp_f32 v183, v183
    v_mfma_f32_16x16x32_bf16 v[218:221], v[112:115], v[196:199], v[218:221]
    v_exp_f32 v178, v178
    v_mfma_f32_16x16x32_bf16 v[194:197], v[74:77], v[174:177], v[242:245]
    s_waitcnt lgkmcnt(1)
    buffer_store_dwordx4 v[162:165], v249, s[12:15], s43 offen sc1
    v_mfma_f32_16x16x32_bf16 v[198:201], v[78:81], v[174:177], v[242:245]
    s_waitcnt lgkmcnt(0)
    buffer_store_dwordx4 v[150:153], v249, s[12:15], s36 offen sc1
    s_add_u32 m0, s55, 32768
    s_add_u32 s37, s33, 26222592
    buffer_load_dwordx4 v248, s[8:11], s37 offen nt lds
    buffer_load_dwordx4 v248, s[8:11], s37 offen offset:2048 nt lds
    s_waitcnt vmcnt(10)
    s_barrier
    s_setprio 2
    ds_read_b128 v[142:145], v246 offset:12288
    ds_read_b128 v[146:149], v247 offset:12288
    ds_read_b128 v[134:137], v246 offset:14336
    ds_read_b128 v[138:141], v247 offset:14336
    v_exp_f32 v179, v179
    v_exp_f32 v184, v184
    v_exp_f32 v185, v185
    v_exp_f32 v188, v188
    v_exp_f32 v189, v189
    v_exp_f32 v190, v190
    v_exp_f32 v191, v191
    v_rcp_f32 v231, v230
    v_cvt_pk_bf16_f32 v181, v180, v181
    v_cvt_pk_bf16_f32 v182, v182, v183
    v_exp_f32 v186, v186
    v_exp_f32 v187, v187
    v_exp_f32 v192, v192
    v_exp_f32 v193, v193
    v_cvt_pk_bf16_f32 v180, v178, v179
    v_cvt_pk_bf16_f32 v183, v184, v185
    v_cvt_pk_bf16_f32 v189, v188, v189
    v_cvt_pk_bf16_f32 v190, v190, v191
    v_mfma_f32_16x16x32_bf16 v[234:237], v[238:241], v[180:183], v[234:237]
    v_cndmask_b32 v231, 0, v231, s[56:57]
    v_cvt_pk_bf16_f32 v188, v186, v187
    v_mfma_f32_16x16x32_bf16 v[214:217], v[102:105], v[180:183], v[214:217]
    v_cvt_pk_bf16_f32 v191, v192, v193
    v_fma_f32 v126, v206, v231, v126
    v_mfma_f32_16x16x32_bf16 v[218:221], v[116:119], v[180:183], v[218:221]
    s_waitcnt lgkmcnt(2)
    v_fma_f32 v127, v207, v231, v127
    v_fma_f32 v128, v208, v231, v128
    v_mfma_f32_16x16x32_bf16 v[158:161], v[2:5], v[142:145], 0
    s_waitcnt lgkmcnt(0)
    v_fma_f32 v129, v209, v231, v129
    v_fma_f32 v130, v210, v231, v130
    v_mfma_f32_16x16x32_bf16 v[162:165], v[6:9], v[142:145], 0
    v_fma_f32 v131, v211, v231, v131
    v_fma_f32 v132, v212, v231, v132
    v_mfma_f32_16x16x32_bf16 v[158:161], v[10:13], v[146:149], v[158:161]
    v_fma_f32 v133, v213, v231, v133
    v_exp_f32 v196, v196
    v_mfma_f32_16x16x32_bf16 v[162:165], v[14:17], v[146:149], v[162:165]
    v_exp_f32 v197, v197
    v_mfma_f32_16x16x32_bf16 v[150:153], v[18:21], v[142:145], 0
    v_exp_f32 v198, v198
    v_mfma_f32_16x16x16_bf16 v[234:237], v[238:239], v[202:203], v[234:237]
    v_exp_f32 v199, v199
    v_cvt_pk_bf16_f32 v166, v158, v159
    v_mfma_f32_16x16x32_bf16 v[154:157], v[22:25], v[142:145], 0
    v_cvt_pk_bf16_f32 v167, v160, v161
    v_cvt_pk_bf16_f32 v168, v162, v163
    v_mfma_f32_16x16x32_bf16 v[178:181], v[82:85], v[174:177], v[242:245]
    v_cvt_pk_bf16_f32 v169, v164, v165
    v_cvt_pk_bf16_f32 v197, v196, v197
    v_mfma_f32_16x16x32_bf16 v[150:153], v[26:29], v[146:149], v[150:153]
    v_rcp_f32 v235, v234
    v_mfma_f32_16x16x32_bf16 v[154:157], v[30:33], v[146:149], v[154:157]
    v_max3_u32 v0, v0, v230, v234
    v_min3_u32 v1, v1, v230, v234
    v_mfma_f32_16x16x32_bf16 v[158:161], v[142:145], v[34:37], 0
    v_exp_f32 v194, v194
    v_mfma_f32_16x16x32_bf16 v[162:165], v[142:145], v[38:41], 0
    s_nop 0
    v_cvt_pk_bf16_f32 v66, v150, v151
    v_cvt_pk_bf16_f32 v67, v152, v153
    v_mfma_f32_16x16x32_bf16 v[158:161], v[146:149], v[42:45], v[158:161]
    ds_read_b128 v[142:145], v246 offset:10240
    v_cvt_pk_bf16_f32 v68, v154, v155
    v_cvt_pk_bf16_f32 v69, v156, v157
    v_mfma_f32_16x16x32_bf16 v[182:185], v[86:89], v[174:177], v[242:245]
    v_exp_f32 v195, v195
    v_mfma_f32_16x16x32_bf16 v[162:165], v[146:149], v[46:49], v[162:165]
    v_exp_f32 v200, v200
    v_mfma_f32_16x16x32_bf16 v[150:153], v[2:5], v[134:137], 0
    ds_read_b128 v[146:149], v247 offset:10240
    v_exp_f32 v201, v201
    v_mfma_f32_16x16x32_bf16 v[154:157], v[6:9], v[134:137], 0
    v_cvt_pk_bf16_f32 v198, v198, v199
    v_cvt_pk_bf16_f32 v196, v194, v195
    v_mfma_f32_16x16x32_bf16 v[150:153], v[10:13], v[138:141], v[150:153]
    v_cvt_pk_bf16_f32 v199, v200, v201
    v_exp_f32 v180, v180
    v_mfma_f32_16x16x32_bf16 v[154:157], v[14:17], v[138:141], v[154:157]
    v_exp_f32 v181, v181
    v_mfma_f32_16x16x32_bf16 v[206:209], v[94:97], v[188:191], 0
    v_cvt_pk_bf16_f32 v94, v158, v159
    v_cvt_pk_bf16_f32 v95, v160, v161
    v_mfma_f32_16x16x32_bf16 v[210:213], v[108:111], v[188:191], 0
    v_cvt_pk_bf16_f32 v108, v162, v163
    v_cvt_pk_bf16_f32 v109, v164, v165
    v_mfma_f32_16x16x32_bf16 v[158:161], v[18:21], v[134:137], 0
    v_cvt_pk_bf16_f32 v170, v150, v151
    v_cvt_pk_bf16_f32 v171, v152, v153
    v_mfma_f32_16x16x16_bf16 v[214:217], v[106:107], v[202:203], v[214:217]
    v_cvt_pk_bf16_f32 v172, v154, v155
    v_cvt_pk_bf16_f32 v173, v156, v157
    v_cvt_pk_bf16_f32 v181, v180, v181
    v_mfma_f32_16x16x32_bf16 v[162:165], v[22:25], v[134:137], 0
    v_exp_f32 v182, v182
    v_mfma_f32_16x16x16_bf16 v[218:221], v[120:121], v[202:203], v[218:221]
    v_exp_f32 v183, v183
    v_exp_f32 v178, v178
    v_mfma_f32_16x16x32_bf16 v[158:161], v[26:29], v[138:141], v[158:161]
    s_waitcnt lgkmcnt(0)
    v_fma_f32 v214, v214, v235, v222
    v_fma_f32 v215, v215, v235, v223
    v_mfma_f32_16x16x32_bf16 v[150:153], v[134:137], v[34:37], 0
    v_fma_f32 v216, v216, v235, v224
    v_fma_f32 v217, v217, v235, v225
    v_mfma_f32_16x16x32_bf16 v[222:225], v[50:53], v[142:145], 0
    v_fma_f32 v218, v218, v235, v226
    v_fma_f32 v219, v219, v235, v227
    v_mfma_f32_16x16x32_bf16 v[222:225], v[58:61], v[146:149], v[222:225]
    v_fma_f32 v220, v220, v235, v228
    v_fma_f32 v221, v221, v235, v229
    v_mfma_f32_16x16x32_bf16 v[162:165], v[30:33], v[138:141], v[162:165]
    v_cvt_pk_bf16_f32 v70, v158, v159
    v_cvt_pk_bf16_f32 v71, v160, v161
    v_mfma_f32_16x16x32_bf16 v[150:153], v[138:141], v[42:45], v[150:153]
    v_exp_f32 v179, v179
    v_mfma_f32_16x16x32_bf16 v[226:229], v[54:57], v[142:145], 0
    v_exp_f32 v184, v184
    v_mfma_f32_16x16x32_bf16 v[226:229], v[62:65], v[146:149], v[226:229]
    ds_read_b128 v[142:145], v246 offset:18432
    v_exp_f32 v185, v185
    v_mfma_f32_16x16x32_bf16 v[206:209], v[98:101], v[196:199], v[206:209]
    ds_read_b128 v[146:149], v247 offset:18432
    v_cvt_pk_bf16_f32 v182, v182, v183
    v_cvt_pk_bf16_f32 v180, v178, v179
    v_mfma_f32_16x16x32_bf16 v[154:157], v[134:137], v[38:41], 0
    v_cvt_pk_bf16_f32 v183, v184, v185
    ds_read_b128 v[134:137], v246 offset:16384
    v_mfma_f32_16x16x32_bf16 v[154:157], v[138:141], v[46:49], v[154:157]
    v_cvt_pk_bf16_f32 v72, v162, v163
    ds_read_b128 v[138:141], v247 offset:16384
    v_mfma_f32_16x16x32_bf16 v[206:209], v[102:105], v[180:183], v[206:209]
    v_cvt_pk_bf16_f32 v73, v164, v165
    v_cvt_pk_bf16_f32 v96, v150, v151
    v_mfma_f32_16x16x32_bf16 v[210:213], v[112:115], v[196:199], v[210:213]
    v_cvt_pk_bf16_f32 v97, v152, v153
    v_cvt_pk_bf16_f32 v214, v214, v215
    v_mfma_f32_16x16x32_bf16 v[210:213], v[116:119], v[180:183], v[210:213]
    v_cvt_pk_bf16_f32 v110, v154, v155
    v_cvt_pk_bf16_f32 v111, v156, v157
    v_mfma_f32_16x16x32_bf16 v[230:233], v[238:241], v[188:191], 0
    v_cvt_pk_bf16_f32 v215, v216, v217
    v_cvt_pk_bf16_f32 v216, v218, v219
    v_mfma_f32_16x16x32_bf16 v[186:189], v[66:69], v[166:169], v[242:245]
    v_cvt_pk_bf16_f32 v217, v220, v221
    v_pk_max_i16 v214, v214, 0
    v_mfma_f32_16x16x32_bf16 v[190:193], v[70:73], v[166:169], v[242:245]
    v_pk_max_i16 v215, v215, 0
    v_pk_max_i16 v216, v216, 0
    v_mfma_f32_16x16x32_bf16 v[230:233], v[238:241], v[196:199], v[230:233]
    v_pk_max_i16 v217, v217, 0
    ds_write_b128 v252, v[214:217] offset:4096
    v_mfma_f32_16x16x32_bf16 v[230:233], v[238:241], v[180:183], v[230:233]
    s_waitcnt lgkmcnt(3)
    v_exp_f32 v188, v188
    v_mfma_f32_16x16x32_bf16 v[194:197], v[66:69], v[170:173], v[242:245]
    s_add_u32 s38, s33, 8192
    v_exp_f32 v189, v189
    v_mfma_f32_16x16x32_bf16 v[198:201], v[70:73], v[170:173], v[242:245]
    s_add_u32 s39, s33, 10240
    v_exp_f32 v190, v190
    s_waitcnt lgkmcnt(1)
    v_mfma_f32_16x16x32_bf16 v[158:161], v[18:21], v[134:137], 0
    s_nop 0
    v_exp_f32 v196, v196
    v_mfma_f32_16x16x32_bf16 v[158:161], v[26:29], v[138:141], v[158:161]
    v_exp_f32 v197, v197
    v_mfma_f32_16x16x32_bf16 v[162:165], v[22:25], v[134:137], 0
    v_exp_f32 v198, v198
    v_mfma_f32_16x16x32_bf16 v[150:153], v[134:137], v[34:37], 0
    v_exp_f32 v199, v199
    v_mfma_f32_16x16x32_bf16 v[154:157], v[134:137], v[38:41], 0
    v_exp_f32 v194, v194
    v_mfma_f32_16x16x32_bf16 v[162:165], v[30:33], v[138:141], v[162:165]
    ds_read_b128 v[134:137], v246 offset:20480
    v_cvt_pk_bf16_f32 v74, v158, v159
    v_cvt_pk_bf16_f32 v75, v160, v161
    v_mfma_f32_16x16x32_bf16 v[158:161], v[18:21], v[142:145], 0
    v_exp_f32 v195, v195
    v_mfma_f32_16x16x32_bf16 v[158:161], v[26:29], v[146:149], v[158:161]
    v_exp_f32 v200, v200
    v_mfma_f32_16x16x32_bf16 v[150:153], v[138:141], v[42:45], v[150:153]
    v_cvt_pk_bf16_f32 v76, v162, v163
    v_cvt_pk_bf16_f32 v77, v164, v165
    v_mfma_f32_16x16x32_bf16 v[154:157], v[138:141], v[46:49], v[154:157]
    v_exp_f32 v201, v201
    v_mfma_f32_16x16x32_bf16 v[162:165], v[22:25], v[142:145], 0
    ds_read_b128 v[138:141], v247 offset:20480
    v_cvt_pk_bf16_f32 v78, v158, v159
    v_cvt_pk_bf16_f32 v79, v160, v161
    v_mfma_f32_16x16x32_bf16 v[158:161], v[90:93], v[174:177], v[242:245]
    v_cvt_pk_bf16_f32 v98, v150, v151
    v_cvt_pk_bf16_f32 v99, v152, v153
    v_mfma_f32_16x16x32_bf16 v[150:153], v[142:145], v[34:37], 0
    v_cvt_pk_bf16_f32 v112, v154, v155
    v_cvt_pk_bf16_f32 v113, v156, v157
    v_mfma_f32_16x16x32_bf16 v[178:181], v[74:77], v[166:169], v[242:245]
    v_cvt_pk_bf16_f32 v197, v196, v197
    v_cvt_pk_bf16_f32 v198, v198, v199
    v_mfma_f32_16x16x32_bf16 v[154:157], v[142:145], v[38:41], 0
    v_exp_f32 v158, v158
    v_mfma_f32_16x16x32_bf16 v[162:165], v[30:33], v[146:149], v[162:165]
    ds_read_b128 v[142:145], v246 offset:22528
    v_cvt_pk_bf16_f32 v204, v158, 0
    v_cvt_pk_bf16_f32 v196, v194, v195
    v_mfma_f32_16x16x32_bf16 v[150:153], v[146:149], v[42:45], v[150:153]
    v_cvt_pk_bf16_f32 v199, v200, v201
    v_cvt_pk_bf16_f32 v189, v188, v189
    v_mfma_f32_16x16x16_bf16 v[230:233], v[238:239], v[204:205], v[230:233]
    v_exp_f32 v191, v191
    v_cvt_pk_bf16_f32 v80, v162, v163
    v_mfma_f32_16x16x16_bf16 v[206:209], v[106:107], v[204:205], v[206:209]
    v_cvt_pk_bf16_f32 v81, v164, v165
    v_exp_f32 v186, v186
    v_mfma_f32_16x16x16_bf16 v[210:213], v[120:121], v[204:205], v[210:213]
    v_cvt_pk_bf16_f32 v100, v150, v151
    v_cvt_pk_bf16_f32 v101, v152, v153
    v_rcp_f32 v231, v230
    v_mfma_f32_16x16x32_bf16 v[154:157], v[146:149], v[46:49], v[154:157]
    s_waitcnt lgkmcnt(1)
    v_fma_f32 v206, v206, v231, v222
    v_fma_f32 v207, v207, v231, v223
    v_mfma_f32_16x16x32_bf16 v[162:165], v[18:21], v[134:137], 0
    ds_read_b128 v[146:149], v247 offset:22528
    v_fma_f32 v208, v208, v231, v224
    v_fma_f32 v209, v209, v231, v225
    v_mfma_f32_16x16x32_bf16 v[150:153], v[22:25], v[134:137], 0
    v_cvt_pk_bf16_f32 v206, v206, v207
    v_fma_f32 v210, v210, v231, v226
    v_mfma_f32_16x16x32_bf16 v[158:161], v[134:137], v[38:41], 0
    v_fma_f32 v211, v211, v231, v227
    v_fma_f32 v212, v212, v231, v228
    v_mfma_f32_16x16x32_bf16 v[162:165], v[26:29], v[138:141], v[162:165]
    v_fma_f32 v213, v213, v231, v229
    v_cvt_pk_bf16_f32 v207, v208, v209
    v_mfma_f32_16x16x32_bf16 v[150:153], v[30:33], v[138:141], v[150:153]
    v_cvt_pk_bf16_f32 v208, v210, v211
    v_cvt_pk_bf16_f32 v209, v212, v213
    v_mfma_f32_16x16x32_bf16 v[158:161], v[138:141], v[46:49], v[158:161]
    v_pk_max_i16 v206, v206, 0
    v_pk_max_i16 v207, v207, 0
    v_mfma_f32_16x16x32_bf16 v[182:185], v[78:81], v[166:169], v[242:245]
    v_pk_max_i16 v208, v208, 0
    v_pk_max_i16 v209, v209, 0
    v_mfma_f32_16x16x32_bf16 v[210:213], v[108:111], v[196:199], 0
    ds_write_b128 v252, v[206:209] offset:6144
    v_cvt_pk_bf16_f32 v114, v154, v155
    v_cvt_pk_bf16_f32 v115, v156, v157
    v_mfma_f32_16x16x32_bf16 v[154:157], v[134:137], v[34:37], 0
    s_add_u32 s40, s33, 13107200
    v_cvt_pk_bf16_f32 v82, v162, v163
    v_cvt_pk_bf16_f32 v83, v164, v165
    v_mfma_f32_16x16x32_bf16 v[154:157], v[138:141], v[42:45], v[154:157]
    ds_read_b128 v[134:137], v246 offset:16384
    v_cvt_pk_bf16_f32 v84, v150, v151
    v_cvt_pk_bf16_f32 v85, v152, v153
    v_mfma_f32_16x16x32_bf16 v[206:209], v[94:97], v[196:199], 0
    ds_read_b128 v[138:141], v247 offset:16384
    v_cvt_pk_bf16_f32 v116, v158, v159
    v_cvt_pk_bf16_f32 v117, v160, v161
    v_mfma_f32_16x16x32_bf16 v[230:233], v[238:241], v[196:199], 0
    s_waitcnt lgkmcnt(3)
    v_cvt_pk_bf16_f32 v102, v154, v155
    v_cvt_pk_bf16_f32 v103, v156, v157
    v_mfma_f32_16x16x32_bf16 v[162:165], v[18:21], v[142:145], 0
    s_add_u32 s41, s33, 13109248
    v_exp_f32 v187, v187
    v_mfma_f32_16x16x32_bf16 v[150:153], v[22:25], v[142:145], 0
    v_exp_f32 v192, v192
    v_mfma_f32_16x16x32_bf16 v[154:157], v[142:145], v[34:37], 0
    v_exp_f32 v193, v193
    v_mfma_f32_16x16x32_bf16 v[158:161], v[142:145], v[38:41], 0
    v_cvt_pk_bf16_f32 v190, v190, v191
    v_cvt_pk_bf16_f32 v188, v186, v187
    v_mfma_f32_16x16x32_bf16 v[162:165], v[26:29], v[146:149], v[162:165]
    ds_read_b128 v[142:145], v246 offset:18432
    v_cvt_pk_bf16_f32 v191, v192, v193
    v_exp_f32 v180, v180
    v_mfma_f32_16x16x32_bf16 v[150:153], v[30:33], v[146:149], v[150:153]
    v_exp_f32 v181, v181
    v_mfma_f32_16x16x32_bf16 v[154:157], v[146:149], v[42:45], v[154:157]
    v_exp_f32 v182, v182
    v_mfma_f32_16x16x32_bf16 v[158:161], v[146:149], v[46:49], v[158:161]
    v_cvt_pk_bf16_f32 v86, v162, v163
    v_cvt_pk_bf16_f32 v87, v164, v165
    v_mfma_f32_16x16x32_bf16 v[194:197], v[82:85], v[166:169], v[242:245]
    ds_read_b128 v[146:149], v247 offset:18432
    v_cvt_pk_bf16_f32 v88, v150, v151
    v_cvt_pk_bf16_f32 v89, v152, v153
    v_mfma_f32_16x16x32_bf16 v[214:217], v[94:97], v[188:191], 0
    s_waitcnt lgkmcnt(4)
    s_barrier
    v_cvt_pk_bf16_f32 v104, v154, v155
    v_cvt_pk_bf16_f32 v105, v156, v157
    v_mfma_f32_16x16x32_bf16 v[198:201], v[86:89], v[166:169], v[242:245]
    ds_read_b128 v[162:165], v253 offset:4096
    v_cvt_pk_bf16_f32 v118, v158, v159
    v_cvt_pk_bf16_f32 v119, v160, v161
    v_mfma_f32_16x16x32_bf16 v[218:221], v[108:111], v[188:191], 0
    s_waitcnt lgkmcnt(3)
    v_exp_f32 v183, v183
    v_mfma_f32_16x16x32_bf16 v[154:157], v[2:5], v[134:137], 0
    ds_read_b128 v[150:153], v253 offset:6144
    v_exp_f32 v178, v178
    v_mfma_f32_16x16x32_bf16 v[158:161], v[6:9], v[134:137], 0
    v_exp_f32 v179, v179
    v_mfma_f32_16x16x32_bf16 v[154:157], v[10:13], v[138:141], v[154:157]
    ds_read_b128 v[134:137], v246 offset:12288
    v_exp_f32 v184, v184
    v_mfma_f32_16x16x32_bf16 v[158:161], v[14:17], v[138:141], v[158:161]
    v_exp_f32 v185, v185
    v_mfma_f32_16x16x32_bf16 v[234:237], v[238:241], v[188:191], 0
    ds_read_b128 v[138:141], v247 offset:12288
    v_cvt_pk_bf16_f32 v181, v180, v181
    v_cvt_pk_bf16_f32 v182, v182, v183
    v_mfma_f32_16x16x32_bf16 v[186:189], v[74:77], v[170:173], v[242:245]
    v_cvt_pk_bf16_f32 v174, v154, v155
    v_cvt_pk_bf16_f32 v175, v156, v157
    v_mfma_f32_16x16x32_bf16 v[190:193], v[78:81], v[170:173], v[242:245]
    s_waitcnt lgkmcnt(4)
    v_cvt_pk_bf16_f32 v176, v158, v159
    v_cvt_pk_bf16_f32 v177, v160, v161
    v_mfma_f32_16x16x32_bf16 v[154:157], v[2:5], v[142:145], 0
    v_cvt_pk_bf16_f32 v180, v178, v179
    v_cvt_pk_bf16_f32 v183, v184, v185
    v_mfma_f32_16x16x32_bf16 v[158:161], v[6:9], v[142:145], 0
    s_waitcnt lgkmcnt(3)
    buffer_store_dwordx4 v[162:165], v249, s[12:15], s38 offen sc1
    v_mfma_f32_16x16x32_bf16 v[154:157], v[10:13], v[146:149], v[154:157]
    ds_read_b128 v[142:145], v246 offset:14336
    v_exp_f32 v196, v196
    v_mfma_f32_16x16x32_bf16 v[158:161], v[14:17], v[146:149], v[158:161]
    s_waitcnt lgkmcnt(3)
    buffer_store_dwordx4 v[150:153], v249, s[12:15], s39 offen sc1
    v_mfma_f32_16x16x32_bf16 v[162:165], v[90:93], v[166:169], v[242:245]
    ds_read_b128 v[146:149], v247 offset:14336
    v_exp_f32 v197, v197
    v_mfma_f32_16x16x32_bf16 v[214:217], v[98:101], v[180:183], v[214:217]
    v_exp_f32 v198, v198
    v_mfma_f32_16x16x32_bf16 v[218:221], v[112:115], v[180:183], v[218:221]
    v_exp_f32 v199, v199
    v_mfma_f32_16x16x32_bf16 v[234:237], v[238:241], v[180:183], v[234:237]
    s_waitcnt lgkmcnt(2)
    v_exp_f32 v194, v194
    v_mfma_f32_16x16x32_bf16 v[178:181], v[82:85], v[170:173], v[242:245]
    v_exp_f32 v195, v195
    v_mfma_f32_16x16x32_bf16 v[182:185], v[86:89], v[170:173], v[242:245]
    v_exp_f32 v200, v200
    v_mfma_f32_16x16x32_bf16 v[222:225], v[50:53], v[134:137], 0
    v_exp_f32 v201, v201
    v_mfma_f32_16x16x32_bf16 v[150:153], v[90:93], v[170:173], v[242:245]
    v_cvt_pk_bf16_f32 v197, v196, v197
    v_cvt_pk_bf16_f32 v198, v198, v199
    v_mfma_f32_16x16x32_bf16 v[226:229], v[54:57], v[134:137], 0
    v_cvt_pk_bf16_f32 v196, v194, v195
    v_cvt_pk_bf16_f32 v199, v200, v201
    v_mfma_f32_16x16x32_bf16 v[222:225], v[58:61], v[138:141], v[222:225]
    ds_read_b128 v[134:137], v246 offset:16384
    v_exp_f32 v188, v188
    v_mfma_f32_16x16x32_bf16 v[234:237], v[238:241], v[196:199], v[234:237]
    s_waitcnt lgkmcnt(1)
    v_exp_f32 v189, v189
    v_mfma_f32_16x16x32_bf16 v[214:217], v[102:105], v[196:199], v[214:217]
    v_exp_f32 v190, v190
    v_mfma_f32_16x16x32_bf16 v[218:221], v[116:119], v[196:199], v[218:221]
    v_exp_f32 v191, v191
    v_mfma_f32_16x16x32_bf16 v[226:229], v[62:65], v[138:141], v[226:229]
    v_exp_f32 v163, v163
    v_mfma_f32_16x16x32_bf16 v[194:197], v[74:77], v[174:177], v[242:245]
    ds_read_b128 v[138:141], v247 offset:16384
    v_exp_f32 v186, v186
    v_mfma_f32_16x16x32_bf16 v[198:201], v[78:81], v[174:177], v[242:245]
    v_exp_f32 v187, v187
    v_exp_f32 v192, v192
    v_exp_f32 v193, v193
    v_cvt_pk_bf16_f32 v189, v188, v189
    v_cvt_pk_bf16_f32 v190, v190, v191
    v_cvt_pk_bf16_f32 v202, 0, v163
    v_cvt_pk_bf16_f32 v188, v186, v187
    v_cvt_pk_bf16_f32 v191, v192, v193
    v_mfma_f32_16x16x16_bf16 v[234:237], v[238:239], v[202:203], v[234:237]
    v_exp_f32 v180, v180
    v_exp_f32 v181, v181
    v_mfma_f32_16x16x32_bf16 v[230:233], v[238:241], v[188:191], v[230:233]
    v_exp_f32 v182, v182
    v_mfma_f32_16x16x16_bf16 v[214:217], v[106:107], v[202:203], v[214:217]
    v_exp_f32 v183, v183
    v_cvt_pk_bf16_f32 v181, v180, v181
    v_mfma_f32_16x16x32_bf16 v[206:209], v[98:101], v[188:191], v[206:209]
    v_exp_f32 v178, v178
    v_mfma_f32_16x16x16_bf16 v[218:221], v[120:121], v[202:203], v[218:221]
    v_exp_f32 v179, v179
    v_cvt_pk_bf16_f32 v182, v182, v183
    v_mfma_f32_16x16x32_bf16 v[210:213], v[112:115], v[188:191], v[210:213]
    v_exp_f32 v184, v184
    v_mfma_f32_16x16x32_bf16 v[186:189], v[66:69], v[174:177], v[242:245]
    s_waitcnt lgkmcnt(0)
    v_exp_f32 v185, v185
    v_mfma_f32_16x16x32_bf16 v[190:193], v[70:73], v[174:177], v[242:245]
    v_cvt_pk_bf16_f32 v180, v178, v179
    v_cvt_pk_bf16_f32 v183, v184, v185
    v_rcp_f32 v235, v234
    v_exp_f32 v151, v151
    v_mfma_f32_16x16x32_bf16 v[230:233], v[238:241], v[180:183], v[230:233]
    v_fma_f32 v214, v214, v235, v222
    v_fma_f32 v215, v215, v235, v223
    v_mfma_f32_16x16x32_bf16 v[206:209], v[102:105], v[180:183], v[206:209]
    v_fma_f32 v216, v216, v235, v224
    v_fma_f32 v217, v217, v235, v225
    v_mfma_f32_16x16x32_bf16 v[210:213], v[116:119], v[180:183], v[210:213]
    v_cvt_pk_bf16_f32 v204, 0, v151
    v_fma_f32 v218, v218, v235, v226
    v_mfma_f32_16x16x32_bf16 v[222:225], v[50:53], v[142:145], 0
    v_fma_f32 v219, v219, v235, v227
    v_fma_f32 v220, v220, v235, v228
    v_mfma_f32_16x16x16_bf16 v[230:233], v[238:239], v[204:205], v[230:233]
    v_fma_f32 v221, v221, v235, v229
    v_cvt_pk_bf16_f32 v214, v214, v215
    v_cvt_pk_bf16_f32 v215, v216, v217
    v_mfma_f32_16x16x32_bf16 v[226:229], v[54:57], v[142:145], 0
    v_cvt_pk_bf16_f32 v216, v218, v219
    v_cvt_pk_bf16_f32 v217, v220, v221
    v_mfma_f32_16x16x32_bf16 v[222:225], v[58:61], v[146:149], v[222:225]
    ds_read_b128 v[142:145], v246 offset:20480
    v_rcp_f32 v231, v230
    v_mfma_f32_16x16x16_bf16 v[206:209], v[106:107], v[204:205], v[206:209]
    v_pk_max_i16 v214, v214, 0
    v_pk_max_i16 v215, v215, 0
    v_pk_max_i16 v216, v216, 0
    v_mfma_f32_16x16x32_bf16 v[226:229], v[62:65], v[146:149], v[226:229]
    v_pk_max_i16 v217, v217, 0
    ds_write_b128 v252, v[214:217] offset:8192
    v_mfma_f32_16x16x16_bf16 v[210:213], v[120:121], v[204:205], v[210:213]
    v_exp_f32 v188, v188
    v_fma_f32 v206, v206, v231, v222
    v_mfma_f32_16x16x32_bf16 v[178:181], v[82:85], v[174:177], v[242:245]
    ds_read_b128 v[146:149], v247 offset:20480
    v_fma_f32 v207, v207, v231, v223
    v_fma_f32 v208, v208, v231, v224
    v_mfma_f32_16x16x32_bf16 v[182:185], v[86:89], v[174:177], v[242:245]
    v_fma_f32 v209, v209, v231, v225
    v_cvt_pk_bf16_f32 v206, v206, v207
    v_mfma_f32_16x16x32_bf16 v[222:225], v[50:53], v[134:137], 0
    v_fma_f32 v210, v210, v231, v226
    v_fma_f32 v211, v211, v231, v227
    v_mfma_f32_16x16x32_bf16 v[222:225], v[58:61], v[138:141], v[222:225]
    v_fma_f32 v212, v212, v231, v228
    v_fma_f32 v213, v213, v231, v229
    v_mfma_f32_16x16x32_bf16 v[226:229], v[54:57], v[134:137], 0
    v_cvt_pk_bf16_f32 v207, v208, v209
    v_cvt_pk_bf16_f32 v208, v210, v211
    v_mfma_f32_16x16x32_bf16 v[226:229], v[62:65], v[138:141], v[226:229]
    ds_read_b128 v[134:137], v246 offset:18432
    v_cvt_pk_bf16_f32 v209, v212, v213
    v_pk_max_i16 v206, v206, 0
    ds_read_b128 v[138:141], v247 offset:18432
    v_pk_max_i16 v207, v207, 0
    v_pk_max_i16 v208, v208, 0
    v_pk_max_i16 v209, v209, 0
    ds_write_b128 v252, v[206:209] offset:10240
    v_exp_f32 v189, v189
    v_exp_f32 v190, v190
    v_exp_f32 v191, v191
    v_exp_f32 v186, v186
    v_exp_f32 v187, v187
    v_exp_f32 v192, v192
    s_waitcnt lgkmcnt(3)
    v_exp_f32 v193, v193
    v_cvt_pk_bf16_f32 v189, v188, v189
    v_cvt_pk_bf16_f32 v190, v190, v191
    v_cvt_pk_bf16_f32 v166, v154, v155
    v_cvt_pk_bf16_f32 v167, v156, v157
    v_mfma_f32_16x16x32_bf16 v[154:157], v[2:5], v[142:145], 0
    v_cvt_pk_bf16_f32 v188, v186, v187
    v_cvt_pk_bf16_f32 v191, v192, v193
    v_mfma_f32_16x16x32_bf16 v[154:157], v[10:13], v[146:149], v[154:157]
    v_exp_f32 v196, v196
    v_mfma_f32_16x16x32_bf16 v[214:217], v[94:97], v[188:191], 0
    v_exp_f32 v197, v197
    v_mfma_f32_16x16x32_bf16 v[218:221], v[108:111], v[188:191], 0
    v_exp_f32 v198, v198
    s_waitcnt lgkmcnt(1)
    v_exp_f32 v199, v199
    v_cvt_pk_bf16_f32 v168, v158, v159
    v_cvt_pk_bf16_f32 v169, v160, v161
    v_mfma_f32_16x16x32_bf16 v[158:161], v[6:9], v[142:145], 0
    v_max3_u32 v0, v0, v230, v234
    v_min3_u32 v1, v1, v230, v234
    v_mfma_f32_16x16x32_bf16 v[234:237], v[238:241], v[188:191], 0
    ds_read_b128 v[142:145], v246 offset:22528
    v_exp_f32 v194, v194
    v_mfma_f32_16x16x32_bf16 v[158:161], v[14:17], v[146:149], v[158:161]
    s_waitcnt lgkmcnt(1)
    s_barrier
    v_exp_f32 v195, v195
    v_mfma_f32_16x16x32_bf16 v[186:189], v[66:69], v[166:169], v[242:245]
    ds_read_b128 v[162:165], v253 offset:8192
    v_exp_f32 v200, v200
    v_mfma_f32_16x16x32_bf16 v[190:193], v[70:73], v[166:169], v[242:245]
    ds_read_b128 v[150:153], v253 offset:10240
    v_exp_f32 v201, v201
    ds_read_b128 v[146:149], v247 offset:22528
    v_cvt_pk_bf16_f32 v197, v196, v197
    v_cvt_pk_bf16_f32 v198, v198, v199
    v_cvt_pk_bf16_f32 v196, v194, v195
    v_cvt_pk_bf16_f32 v199, v200, v201
    v_exp_f32 v180, v180
    v_exp_f32 v181, v181
    v_mfma_f32_16x16x32_bf16 v[234:237], v[238:241], v[196:199], v[234:237]
    s_add_u32 s42, s33, 13111296
    v_exp_f32 v182, v182
    v_mfma_f32_16x16x32_bf16 v[214:217], v[98:101], v[196:199], v[214:217]
    s_add_u32 s43, s33, 13113344
    v_exp_f32 v183, v183
    v_mfma_f32_16x16x32_bf16 v[218:221], v[112:115], v[196:199], v[218:221]
    v_exp_f32 v178, v178
    v_mfma_f32_16x16x32_bf16 v[194:197], v[74:77], v[166:169], v[242:245]
    v_exp_f32 v179, v179
    v_mfma_f32_16x16x32_bf16 v[198:201], v[78:81], v[166:169], v[242:245]
    v_exp_f32 v184, v184
    v_exp_f32 v185, v185
    v_cvt_pk_bf16_f32 v181, v180, v181
    v_cvt_pk_bf16_f32 v182, v182, v183
    v_cvt_pk_bf16_f32 v180, v178, v179
    v_cvt_pk_bf16_f32 v183, v184, v185
    v_cvt_pk_bf16_f32 v170, v154, v155
    v_cvt_pk_bf16_f32 v171, v156, v157
    v_mfma_f32_16x16x32_bf16 v[234:237], v[238:241], v[180:183], v[234:237]
    s_waitcnt lgkmcnt(2)
    buffer_store_dwordx4 v[162:165], v249, s[12:15], s40 offen sc1
    v_mfma_f32_16x16x32_bf16 v[154:157], v[122:125], v[70:73], v[242:245]
    s_waitcnt lgkmcnt(1)
    buffer_store_dwordx4 v[150:153], v249, s[12:15], s41 offen sc1
    v_mfma_f32_16x16x32_bf16 v[162:165], v[90:93], v[174:177], v[242:245]
    s_waitcnt lgkmcnt(0)
    v_cvt_pk_bf16_f32 v172, v158, v159
    v_cvt_pk_bf16_f32 v173, v160, v161
    v_mfma_f32_16x16x32_bf16 v[150:153], v[122:125], v[66:69], v[242:245]
    v_exp_f32 v188, v188
    v_mfma_f32_16x16x32_bf16 v[158:161], v[122:125], v[74:77], v[242:245]
    v_exp_f32 v189, v189
    v_mfma_f32_16x16x32_bf16 v[214:217], v[102:105], v[180:183], v[214:217]
    v_exp_f32 v163, v163
    v_mfma_f32_16x16x32_bf16 v[218:221], v[116:119], v[180:183], v[218:221]
    v_cvt_pk_bf16_f32 v202, 0, v163
    v_cvt_pk_bf16_f32 v189, v188, v189
    v_mfma_f32_16x16x32_bf16 v[162:165], v[122:125], v[78:81], v[242:245]
    v_exp_f32 v190, v190
    v_mfma_f32_16x16x16_bf16 v[234:237], v[238:239], v[202:203], v[234:237]
    v_exp_f32 v191, v191
    v_exp_f32 v186, v186
    v_mfma_f32_16x16x16_bf16 v[214:217], v[106:107], v[202:203], v[214:217]
    v_exp_f32 v187, v187
    v_cvt_pk_bf16_f32 v190, v190, v191
    v_mfma_f32_16x16x16_bf16 v[218:221], v[120:121], v[202:203], v[218:221]
    v_exp_f32 v192, v192
    v_cvt_pk_bf16_f32 v188, v186, v187
    v_exp_f32 v193, v193
    v_exp_f32 v178, v151
    v_mfma_f32_16x16x32_bf16 v[150:153], v[122:125], v[82:85], v[242:245]
    v_exp_f32 v179, v155
    v_mfma_f32_16x16x32_bf16 v[154:157], v[122:125], v[86:89], v[242:245]
    v_exp_f32 v180, v159
    v_mfma_f32_16x16x32_bf16 v[158:161], v[122:125], v[90:93], v[242:245]
    v_cvt_pk_bf16_f32 v191, v192, v193
    v_max3_u32 v0, v0, v230, v234
    v_min3_u32 v1, v1, v230, v234
    v_mfma_f32_16x16x32_bf16 v[206:209], v[94:97], v[188:191], 0
    v_exp_f32 v181, v163
    v_mfma_f32_16x16x32_bf16 v[210:213], v[108:111], v[188:191], 0
    v_cvt_pk_bf16_f32 v178, v178, v179
    v_cvt_pk_bf16_f32 v180, v180, v181
    v_mfma_f32_16x16x32_bf16 v[230:233], v[238:241], v[188:191], 0
    ds_write_b16 v250, v178 offset:0
    v_rcp_f32 v235, v234
    v_mfma_f32_16x16x32_bf16 v[186:189], v[82:85], v[166:169], v[242:245]
    ds_write_b16_d16_hi v250, v178 offset:32
    v_exp_f32 v182, v151
    v_mfma_f32_16x16x32_bf16 v[190:193], v[86:89], v[166:169], v[242:245]
    ds_write_b16 v250, v180 offset:64
    v_exp_f32 v183, v155
    v_mfma_f32_16x16x32_bf16 v[162:165], v[2:5], v[142:145], 0
    ds_write_b16_d16_hi v250, v180 offset:96
    v_fma_f32 v214, v214, v235, v222
    v_fma_f32 v215, v215, v235, v223
    v_mfma_f32_16x16x32_bf16 v[150:153], v[6:9], v[142:145], 0
    v_fma_f32 v216, v216, v235, v224
    v_fma_f32 v217, v217, v235, v225
    v_mfma_f32_16x16x32_bf16 v[222:225], v[50:53], v[134:137], 0
    v_fma_f32 v218, v218, v235, v226
    v_fma_f32 v219, v219, v235, v227
    v_mfma_f32_16x16x32_bf16 v[222:225], v[58:61], v[138:141], v[222:225]
    v_fma_f32 v220, v220, v235, v228
    v_fma_f32 v221, v221, v235, v229
    v_mfma_f32_16x16x32_bf16 v[226:229], v[54:57], v[134:137], 0
    v_exp_f32 v196, v196
    v_mfma_f32_16x16x32_bf16 v[226:229], v[62:65], v[138:141], v[226:229]
    v_exp_f32 v197, v197
    v_mfma_f32_16x16x32_bf16 v[154:157], v[90:93], v[166:169], v[242:245]
    v_exp_f32 v198, v198
    v_mfma_f32_16x16x32_bf16 v[162:165], v[10:13], v[146:149], v[162:165]
    v_exp_f32 v199, v199
    v_mfma_f32_16x16x32_bf16 v[150:153], v[14:17], v[146:149], v[150:153]
    v_exp_f32 v184, v159
    v_mfma_f32_16x16x32_bf16 v[178:181], v[74:77], v[170:173], v[242:245]
    v_exp_f32 v194, v194
    v_exp_f32 v195, v195
    v_exp_f32 v200, v200
    v_exp_f32 v201, v201
    v_cvt_pk_bf16_f32 v182, v182, v183
    v_cvt_pk_bf16_f32 v197, v196, v197
    v_cvt_pk_bf16_f32 v198, v198, v199
    v_cndmask_b32 v184, 0, v184, s[58:59]
    v_cvt_pk_bf16_f32 v196, v194, v195
    v_cvt_pk_bf16_f32 v199, v200, v201
    v_cvt_pk_bf16_f32 v184, v184, 0
    v_exp_f32 v188, v188
    v_mfma_f32_16x16x32_bf16 v[230:233], v[238:241], v[196:199], v[230:233]
    ds_write_b16 v250, v182 offset:128
    v_exp_f32 v189, v189
    v_mfma_f32_16x16x32_bf16 v[206:209], v[98:101], v[196:199], v[206:209]
    ds_write_b16_d16_hi v250, v182 offset:160
    v_exp_f32 v190, v190
    v_mfma_f32_16x16x32_bf16 v[210:213], v[112:115], v[196:199], v[210:213]
    ds_write_b16 v250, v184 offset:192
    v_exp_f32 v191, v191
    v_mfma_f32_16x16x32_bf16 v[194:197], v[66:69], v[170:173], v[242:245]
    ds_read2_b64 v[134:137], v251 offset0:0 offset1:4
    v_exp_f32 v186, v186
    v_mfma_f32_16x16x32_bf16 v[198:201], v[70:73], v[170:173], v[242:245]
    ds_read2_b64 v[138:141], v251 offset0:8 offset1:12
    v_exp_f32 v187, v187
    v_mfma_f32_16x16x32_bf16 v[182:185], v[78:81], v[170:173], v[242:245]
    ds_read2_b64 v[142:145], v251 offset0:16 offset1:20
    v_exp_f32 v192, v192
    ds_read_b64 v[146:147], v251 offset:192
    v_exp_f32 v193, v193
    v_cvt_pk_bf16_f32 v189, v188, v189
    v_cvt_pk_bf16_f32 v190, v190, v191
    v_cvt_pk_bf16_f32 v188, v186, v187
    v_cvt_pk_bf16_f32 v191, v192, v193
    v_exp_f32 v155, v155
    v_cvt_pk_bf16_f32 v214, v214, v215
    v_mfma_f32_16x16x32_bf16 v[230:233], v[238:241], v[188:191], v[230:233]
    v_cvt_pk_bf16_f32 v204, 0, v155
    v_cvt_pk_bf16_f32 v215, v216, v217
    v_mfma_f32_16x16x32_bf16 v[206:209], v[102:105], v[188:191], v[206:209]
    v_cvt_pk_bf16_f32 v216, v218, v219
    v_cvt_pk_bf16_f32 v217, v220, v221
    v_mfma_f32_16x16x32_bf16 v[210:213], v[116:119], v[188:191], v[210:213]
    v_pk_max_i16 v214, v214, 0
    v_pk_max_i16 v215, v215, 0
    v_mfma_f32_16x16x16_bf16 v[230:233], v[238:239], v[204:205], v[230:233]
    v_pk_max_i16 v216, v216, 0
    v_pk_max_i16 v217, v217, 0
    v_cvt_pk_bf16_f32 v174, v162, v163
    v_mfma_f32_16x16x16_bf16 v[206:209], v[106:107], v[204:205], v[206:209]
    v_cvt_pk_bf16_f32 v175, v164, v165
    ds_write_b128 v252, v[214:217] offset:12288
    v_cvt_pk_bf16_f32 v176, v150, v151
    v_mfma_f32_16x16x16_bf16 v[210:213], v[120:121], v[204:205], v[210:213]
    v_rcp_f32 v231, v230
    v_cvt_pk_bf16_f32 v177, v152, v153
    v_mfma_f32_16x16x32_bf16 v[150:153], v[90:93], v[170:173], v[242:245]
    s_nop 0
    v_fma_f32 v206, v206, v231, v222
    v_fma_f32 v207, v207, v231, v223
    v_mfma_f32_16x16x32_bf16 v[186:189], v[82:85], v[170:173], v[242:245]
    v_fma_f32 v208, v208, v231, v224
    v_fma_f32 v209, v209, v231, v225
    v_mfma_f32_16x16x32_bf16 v[190:193], v[86:89], v[170:173], v[242:245]
    s_waitcnt lgkmcnt(1)
    v_cvt_pk_bf16_f32 v206, v206, v207
    v_fma_f32 v210, v210, v231, v226
    v_mfma_f32_16x16x32_bf16 v[234:237], v[238:241], v[134:137], 0
    v_fma_f32 v211, v211, v231, v227
    v_fma_f32 v212, v212, v231, v228
    v_mfma_f32_16x16x32_bf16 v[214:217], v[94:97], v[134:137], 0
    v_fma_f32 v213, v213, v231, v229
    v_cvt_pk_bf16_f32 v207, v208, v209
    v_mfma_f32_16x16x32_bf16 v[218:221], v[108:111], v[134:137], 0
    v_cvt_pk_bf16_f32 v208, v210, v211
    v_cvt_pk_bf16_f32 v209, v212, v213
    v_mfma_f32_16x16x32_bf16 v[234:237], v[238:241], v[138:141], v[234:237]
    ds_read_b128 v[134:137], v246 offset:20480
    v_pk_max_i16 v206, v206, 0
    v_pk_max_i16 v207, v207, 0
    v_mfma_f32_16x16x32_bf16 v[214:217], v[98:101], v[138:141], v[214:217]
    v_pk_max_i16 v208, v208, 0
    v_pk_max_i16 v209, v209, 0
    v_mfma_f32_16x16x32_bf16 v[218:221], v[112:115], v[138:141], v[218:221]
    ds_write_b128 v252, v[206:209] offset:14336
    ds_read_b128 v[138:141], v247 offset:20480
    v_exp_f32 v151, v151
    v_mfma_f32_16x16x32_bf16 v[234:237], v[238:241], v[142:145], v[234:237]
    v_exp_f32 v196, v196
    v_mfma_f32_16x16x32_bf16 v[214:217], v[102:105], v[142:145], v[214:217]
    v_exp_f32 v197, v197
    v_mfma_f32_16x16x32_bf16 v[218:221], v[116:119], v[142:145], v[218:221]
    v_exp_f32 v198, v198
    v_exp_f32 v199, v199
    v_mfma_f32_16x16x16_bf16 v[234:237], v[238:239], v[146:147], v[234:237]
    v_cvt_pk_bf16_f32 v202, 0, v151
    v_exp_f32 v194, v194
    v_mfma_f32_16x16x16_bf16 v[214:217], v[106:107], v[146:147], v[214:217]
    v_exp_f32 v195, v195
    v_cvt_pk_bf16_f32 v197, v196, v197
    v_mfma_f32_16x16x16_bf16 v[218:221], v[120:121], v[146:147], v[218:221]
    v_exp_f32 v200, v200
    v_cvt_pk_bf16_f32 v198, v198, v199
    v_exp_f32 v201, v201
    v_cvt_pk_bf16_f32 v196, v194, v195
    v_cvt_pk_bf16_f32 v199, v200, v201
    v_max3_u32 v0, v0, v230, v234
    v_min3_u32 v1, v1, v230, v234
    v_mfma_f32_16x16x32_bf16 v[206:209], v[94:97], v[196:199], 0
    v_exp_f32 v180, v180
    v_mfma_f32_16x16x32_bf16 v[210:213], v[108:111], v[196:199], 0
    s_waitcnt lgkmcnt(0)
    v_exp_f32 v181, v181
    v_mfma_f32_16x16x32_bf16 v[222:225], v[50:53], v[134:137], 0
    v_exp_f32 v182, v182
    v_mfma_f32_16x16x32_bf16 v[226:229], v[54:57], v[134:137], 0
    v_exp_f32 v183, v183
    v_mfma_f32_16x16x32_bf16 v[222:225], v[58:61], v[138:141], v[222:225]
    s_barrier
    ds_read_b128 v[158:161], v253 offset:12288
    ds_read_b128 v[162:165], v253 offset:14336
    v_mfma_f32_16x16x32_bf16 v[226:229], v[62:65], v[138:141], v[226:229]
    v_exp_f32 v178, v178
    v_mfma_f32_16x16x32_bf16 v[230:233], v[238:241], v[196:199], 0
    v_exp_f32 v179, v179
    v_mfma_f32_16x16x32_bf16 v[194:197], v[66:69], v[174:177], v[242:245]
    v_exp_f32 v184, v184
    v_mfma_f32_16x16x32_bf16 v[198:201], v[70:73], v[174:177], v[242:245]
    v_exp_f32 v185, v185
    v_cvt_pk_bf16_f32 v181, v180, v181
    v_cvt_pk_bf16_f32 v182, v182, v183
    v_cvt_pk_bf16_f32 v180, v178, v179
    v_cvt_pk_bf16_f32 v183, v184, v185
    v_exp_f32 v188, v188
    v_exp_f32 v189, v189
    v_mfma_f32_16x16x32_bf16 v[230:233], v[238:241], v[180:183], v[230:233]
    v_exp_f32 v190, v190
    v_mfma_f32_16x16x32_bf16 v[206:209], v[98:101], v[180:183], v[206:209]
    v_exp_f32 v191, v191
    v_mfma_f32_16x16x32_bf16 v[210:213], v[112:115], v[180:183], v[210:213]
    v_exp_f32 v186, v186
    v_mfma_f32_16x16x32_bf16 v[178:181], v[74:77], v[174:177], v[242:245]
    v_exp_f32 v187, v187
    v_mfma_f32_16x16x32_bf16 v[182:185], v[78:81], v[174:177], v[242:245]
    s_waitcnt lgkmcnt(1)
    buffer_store_dwordx4 v[158:161], v249, s[12:15], s42 offen sc1
    s_waitcnt lgkmcnt(0)
    buffer_store_dwordx4 v[162:165], v249, s[12:15], s43 offen sc1
    s_waitcnt vmcnt(6)
    s_barrier
    s_setprio 1
    s_add_u32 m0, s55, 0
    s_add_u32 s45, s33, 39321600
    buffer_load_dwordx4 v248, s[8:11], s45 offen nt lds
    buffer_load_dwordx4 v248, s[8:11], s45 offen offset:2048 nt lds
    s_add_u32 m0, s55, 4096
    s_add_u32 s45, s33, 39325696
    buffer_load_dwordx4 v248, s[8:11], s45 offen nt lds
    buffer_load_dwordx4 v248, s[8:11], s45 offen offset:2048 nt lds
    s_add_u32 m0, s55, 8192
    s_add_u32 s45, s33, 39329792
    buffer_load_dwordx4 v248, s[8:11], s45 offen nt lds
    buffer_load_dwordx4 v248, s[8:11], s45 offen offset:2048 nt lds
    ds_read_b128 v[142:145], v246 offset:24576
    ds_read_b128 v[146:149], v247 offset:24576
    ds_read_b128 v[134:137], v246 offset:26624
    ds_read_b128 v[138:141], v247 offset:26624
    v_exp_f32 v192, v192
    v_exp_f32 v193, v193
    v_exp_f32 v196, v196
    v_exp_f32 v197, v197
    v_exp_f32 v198, v198
    v_exp_f32 v199, v199
    v_rcp_f32 v235, v234
    v_cvt_pk_bf16_f32 v189, v188, v189
    v_cvt_pk_bf16_f32 v190, v190, v191
    v_exp_f32 v194, v194
    v_exp_f32 v195, v195
    v_exp_f32 v200, v200
    v_exp_f32 v201, v201
    v_cvt_pk_bf16_f32 v188, v186, v187
    v_cvt_pk_bf16_f32 v191, v192, v193
    v_cvt_pk_bf16_f32 v197, v196, v197
    v_cvt_pk_bf16_f32 v198, v198, v199
    v_mfma_f32_16x16x32_bf16 v[230:233], v[238:241], v[188:191], v[230:233]
    v_cndmask_b32 v235, 0, v235, s[58:59]
    v_cvt_pk_bf16_f32 v196, v194, v195
    v_mfma_f32_16x16x32_bf16 v[206:209], v[102:105], v[188:191], v[206:209]
    v_cvt_pk_bf16_f32 v199, v200, v201
    v_fma_f32 v126, v214, v235, v126
    v_mfma_f32_16x16x32_bf16 v[210:213], v[116:119], v[188:191], v[210:213]
    s_waitcnt lgkmcnt(2)
    v_fma_f32 v127, v215, v235, v127
    v_fma_f32 v128, v216, v235, v128
    v_mfma_f32_16x16x32_bf16 v[154:157], v[2:5], v[142:145], 0
    s_waitcnt lgkmcnt(0)
    v_fma_f32 v129, v217, v235, v129
    v_fma_f32 v130, v218, v235, v130
    v_mfma_f32_16x16x32_bf16 v[158:161], v[6:9], v[142:145], 0
    v_fma_f32 v131, v219, v235, v131
    v_fma_f32 v132, v220, v235, v132
    v_mfma_f32_16x16x32_bf16 v[154:157], v[10:13], v[146:149], v[154:157]
    v_fma_f32 v133, v221, v235, v133
    v_exp_f32 v180, v180
    v_mfma_f32_16x16x32_bf16 v[158:161], v[14:17], v[146:149], v[158:161]
    v_exp_f32 v181, v181
    v_mfma_f32_16x16x32_bf16 v[162:165], v[18:21], v[142:145], 0
    v_exp_f32 v182, v182
    v_mfma_f32_16x16x16_bf16 v[230:233], v[238:239], v[202:203], v[230:233]
    v_exp_f32 v183, v183
    v_cvt_pk_bf16_f32 v166, v154, v155
    v_mfma_f32_16x16x32_bf16 v[186:189], v[82:85], v[174:177], v[242:245]
    v_cvt_pk_bf16_f32 v167, v156, v157
    v_cvt_pk_bf16_f32 v168, v158, v159
    v_mfma_f32_16x16x32_bf16 v[150:153], v[22:25], v[142:145], 0
    v_cvt_pk_bf16_f32 v169, v160, v161
    v_cvt_pk_bf16_f32 v181, v180, v181
    v_mfma_f32_16x16x32_bf16 v[162:165], v[26:29], v[146:149], v[162:165]
    v_rcp_f32 v231, v230
    v_mfma_f32_16x16x32_bf16 v[150:153], v[30:33], v[146:149], v[150:153]
    v_exp_f32 v178, v178
    v_mfma_f32_16x16x32_bf16 v[154:157], v[142:145], v[34:37], 0
    v_exp_f32 v179, v179
    v_mfma_f32_16x16x32_bf16 v[158:161], v[142:145], v[38:41], 0
    v_exp_f32 v184, v184
    v_mfma_f32_16x16x32_bf16 v[154:157], v[146:149], v[42:45], v[154:157]
    ds_read_b128 v[142:145], v246 offset:22528
    v_cvt_pk_bf16_f32 v66, v162, v163
    v_cvt_pk_bf16_f32 v67, v164, v165
    v_mfma_f32_16x16x32_bf16 v[190:193], v[86:89], v[174:177], v[242:245]
    v_cvt_pk_bf16_f32 v68, v150, v151
    v_cvt_pk_bf16_f32 v69, v152, v153
    v_mfma_f32_16x16x32_bf16 v[158:161], v[146:149], v[46:49], v[158:161]
    v_exp_f32 v185, v185
    v_mfma_f32_16x16x32_bf16 v[162:165], v[2:5], v[134:137], 0
    ds_read_b128 v[146:149], v247 offset:22528
    v_cvt_pk_bf16_f32 v182, v182, v183
    v_cvt_pk_bf16_f32 v180, v178, v179
    v_mfma_f32_16x16x32_bf16 v[150:153], v[6:9], v[134:137], 0
    v_cvt_pk_bf16_f32 v183, v184, v185
    v_exp_f32 v188, v188
    v_mfma_f32_16x16x16_bf16 v[206:209], v[106:107], v[202:203], v[206:209]
    v_exp_f32 v189, v189
    v_exp_f32 v190, v190
    v_mfma_f32_16x16x16_bf16 v[210:213], v[120:121], v[202:203], v[210:213]
    v_exp_f32 v191, v191
    v_cvt_pk_bf16_f32 v189, v188, v189
    v_mfma_f32_16x16x32_bf16 v[162:165], v[10:13], v[138:141], v[162:165]
    v_exp_f32 v186, v186
    v_mfma_f32_16x16x32_bf16 v[150:153], v[14:17], v[138:141], v[150:153]
    v_fma_f32 v206, v206, v231, v222
    v_fma_f32 v207, v207, v231, v223
    v_mfma_f32_16x16x32_bf16 v[214:217], v[94:97], v[196:199], 0
    v_cvt_pk_bf16_f32 v94, v154, v155
    v_cvt_pk_bf16_f32 v95, v156, v157
    v_mfma_f32_16x16x32_bf16 v[218:221], v[108:111], v[196:199], 0
    v_cvt_pk_bf16_f32 v108, v158, v159
    v_cvt_pk_bf16_f32 v109, v160, v161
    v_mfma_f32_16x16x32_bf16 v[154:157], v[18:21], v[134:137], 0
    v_cvt_pk_bf16_f32 v170, v162, v163
    v_cvt_pk_bf16_f32 v171, v164, v165
    v_mfma_f32_16x16x32_bf16 v[158:161], v[22:25], v[134:137], 0
    v_cvt_pk_bf16_f32 v172, v150, v151
    v_cvt_pk_bf16_f32 v173, v152, v153
    v_mfma_f32_16x16x32_bf16 v[154:157], v[26:29], v[138:141], v[154:157]
    s_waitcnt lgkmcnt(0)
    v_fma_f32 v208, v208, v231, v224
    v_fma_f32 v209, v209, v231, v225
    v_mfma_f32_16x16x32_bf16 v[222:225], v[50:53], v[142:145], 0
    v_fma_f32 v210, v210, v231, v226
    v_fma_f32 v211, v211, v231, v227
    v_mfma_f32_16x16x32_bf16 v[222:225], v[58:61], v[146:149], v[222:225]
    v_fma_f32 v212, v212, v231, v228
    v_fma_f32 v213, v213, v231, v229
    v_mfma_f32_16x16x32_bf16 v[158:161], v[30:33], v[138:141], v[158:161]
    v_cvt_pk_bf16_f32 v70, v154, v155
    v_cvt_pk_bf16_f32 v71, v156, v157
    v_mfma_f32_16x16x32_bf16 v[226:229], v[54:57], v[142:145], 0
    v_exp_f32 v187, v187
    v_mfma_f32_16x16x32_bf16 v[226:229], v[62:65], v[146:149], v[226:229]
    ds_read_b128 v[142:145], v246 offset:30720
    v_exp_f32 v192, v192
    v_mfma_f32_16x16x32_bf16 v[214:217], v[98:101], v[180:183], v[214:217]
    ds_read_b128 v[146:149], v247 offset:30720
    v_exp_f32 v193, v193
    v_mfma_f32_16x16x32_bf16 v[234:237], v[238:241], v[196:199], 0
    v_cvt_pk_bf16_f32 v190, v190, v191
    v_cvt_pk_bf16_f32 v188, v186, v187
    v_mfma_f32_16x16x32_bf16 v[194:197], v[66:69], v[166:169], v[242:245]
    v_cvt_pk_bf16_f32 v191, v192, v193
    v_cvt_pk_bf16_f32 v72, v158, v159
    v_mfma_f32_16x16x32_bf16 v[234:237], v[238:241], v[180:183], v[234:237]
    v_cvt_pk_bf16_f32 v73, v160, v161
    v_cvt_pk_bf16_f32 v206, v206, v207
    v_mfma_f32_16x16x32_bf16 v[234:237], v[238:241], v[188:191], v[234:237]
    v_cvt_pk_bf16_f32 v207, v208, v209
    v_cvt_pk_bf16_f32 v208, v210, v211
    v_mfma_f32_16x16x32_bf16 v[198:201], v[70:73], v[166:169], v[242:245]
    v_cvt_pk_bf16_f32 v209, v212, v213
    v_pk_max_i16 v206, v206, 0
    v_mfma_f32_16x16x32_bf16 v[162:165], v[134:137], v[34:37], 0
    v_pk_max_i16 v207, v207, 0
    v_pk_max_i16 v208, v208, 0
    v_mfma_f32_16x16x32_bf16 v[150:153], v[134:137], v[38:41], 0
    v_pk_max_i16 v209, v209, 0
    ds_read_b128 v[134:137], v246 offset:28672
    v_mfma_f32_16x16x32_bf16 v[162:165], v[138:141], v[42:45], v[162:165]
    ds_write_b128 v252, v[206:209] offset:16384
    v_exp_f32 v196, v196
    v_mfma_f32_16x16x32_bf16 v[150:153], v[138:141], v[46:49], v[150:153]
    s_add_u32 s36, s33, 13115392
    ds_read_b128 v[138:141], v247 offset:28672
    v_exp_f32 v197, v197
    v_mfma_f32_16x16x32_bf16 v[218:221], v[112:115], v[180:183], v[218:221]
    s_waitcnt lgkmcnt(3)
    v_cvt_pk_bf16_f32 v96, v162, v163
    v_cvt_pk_bf16_f32 v97, v164, v165
    v_mfma_f32_16x16x32_bf16 v[214:217], v[102:105], v[188:191], v[214:217]
    s_add_u32 s37, s33, 13117440
    v_cvt_pk_bf16_f32 v110, v150, v151
    v_cvt_pk_bf16_f32 v111, v152, v153
    v_mfma_f32_16x16x32_bf16 v[178:181], v[66:69], v[170:173], v[242:245]
    v_exp_f32 v198, v198
    v_mfma_f32_16x16x32_bf16 v[218:221], v[116:119], v[188:191], v[218:221]
    v_exp_f32 v199, v199
    v_mfma_f32_16x16x32_bf16 v[182:185], v[70:73], v[170:173], v[242:245]
    v_exp_f32 v194, v194
    v_exp_f32 v195, v195
    v_exp_f32 v200, v200
    v_exp_f32 v201, v201
    v_exp_f32 v180, v180
    v_exp_f32 v181, v181
    v_exp_f32 v178, v178
    v_exp_f32 v179, v179
    v_exp_f32 v182, v182
    v_exp_f32 v183, v183
    s_waitcnt lgkmcnt(0)
    v_mfma_f32_16x16x32_bf16 v[154:157], v[18:21], v[134:137], 0
    v_exp_f32 v184, v184
    v_mfma_f32_16x16x32_bf16 v[154:157], v[26:29], v[138:141], v[154:157]
    v_exp_f32 v185, v185
    v_mfma_f32_16x16x32_bf16 v[158:161], v[22:25], v[134:137], 0
    v_cvt_pk_bf16_f32 v181, v180, v181
    v_cvt_pk_bf16_f32 v182, v182, v183
    v_mfma_f32_16x16x32_bf16 v[158:161], v[30:33], v[138:141], v[158:161]
    v_cvt_pk_bf16_f32 v180, v178, v179
    v_cvt_pk_bf16_f32 v183, v184, v185
    v_mfma_f32_16x16x32_bf16 v[162:165], v[134:137], v[34:37], 0
    v_cvt_pk_bf16_f32 v74, v154, v155
    v_cvt_pk_bf16_f32 v75, v156, v157
    v_mfma_f32_16x16x32_bf16 v[162:165], v[138:141], v[42:45], v[162:165]
    v_cvt_pk_bf16_f32 v197, v196, v197
    v_cvt_pk_bf16_f32 v198, v198, v199
    v_mfma_f32_16x16x32_bf16 v[154:157], v[18:21], v[142:145], 0
    v_cvt_pk_bf16_f32 v76, v158, v159
    v_cvt_pk_bf16_f32 v77, v160, v161
    v_mfma_f32_16x16x32_bf16 v[154:157], v[26:29], v[146:149], v[154:157]
    v_cvt_pk_bf16_f32 v196, v194, v195
    v_cvt_pk_bf16_f32 v199, v200, v201
    v_mfma_f32_16x16x32_bf16 v[186:189], v[74:77], v[166:169], v[242:245]
    v_cvt_pk_bf16_f32 v98, v162, v163
    v_cvt_pk_bf16_f32 v99, v164, v165
    v_mfma_f32_16x16x32_bf16 v[150:153], v[134:137], v[38:41], 0
    v_mov_b32 v202, 0
    ds_read_b128 v[134:137], v246 offset:32768
    v_mfma_f32_16x16x32_bf16 v[150:153], v[138:141], v[46:49], v[150:153]
    v_cvt_pk_bf16_f32 v78, v154, v155
    v_cvt_pk_bf16_f32 v79, v156, v157
    v_mfma_f32_16x16x32_bf16 v[154:157], v[90:93], v[174:177], v[242:245]
    ds_read_b128 v[138:141], v247 offset:32768
    v_exp_f32 v188, v188
    v_mfma_f32_16x16x32_bf16 v[158:161], v[22:25], v[142:145], 0
    v_exp_f32 v189, v189
    v_mfma_f32_16x16x32_bf16 v[158:161], v[30:33], v[146:149], v[158:161]
    v_cvt_pk_bf16_f32 v112, v150, v151
    v_cvt_pk_bf16_f32 v113, v152, v153
    v_mfma_f32_16x16x32_bf16 v[162:165], v[142:145], v[34:37], 0
    v_exp_f32 v155, v155
    v_mfma_f32_16x16x32_bf16 v[162:165], v[146:149], v[42:45], v[162:165]
    v_cvt_pk_bf16_f32 v204, 0, v155
    v_cvt_pk_bf16_f32 v189, v188, v189
    v_mfma_f32_16x16x32_bf16 v[150:153], v[142:145], v[38:41], 0
    v_cvt_pk_bf16_f32 v80, v158, v159
    v_cvt_pk_bf16_f32 v81, v160, v161
    v_mfma_f32_16x16x16_bf16 v[234:237], v[238:239], v[204:205], v[234:237]
    ds_read_b128 v[142:145], v246 offset:34816
    v_exp_f32 v186, v186
    v_mfma_f32_16x16x32_bf16 v[190:193], v[78:81], v[166:169], v[242:245]
    v_cvt_pk_bf16_f32 v100, v162, v163
    v_cvt_pk_bf16_f32 v101, v164, v165
    v_mfma_f32_16x16x16_bf16 v[214:217], v[106:107], v[204:205], v[214:217]
    v_exp_f32 v187, v187
    v_mfma_f32_16x16x16_bf16 v[218:221], v[120:121], v[204:205], v[218:221]
    v_rcp_f32 v235, v234
    v_max3_u32 v0, v0, v230, v234
    v_mfma_f32_16x16x32_bf16 v[150:153], v[146:149], v[46:49], v[150:153]
    s_waitcnt lgkmcnt(1)
    ds_read_b128 v[146:149], v247 offset:34816
    v_min3_u32 v1, v1, v230, v234
    v_mfma_f32_16x16x32_bf16 v[158:161], v[18:21], v[134:137], 0
    v_fma_f32 v214, v214, v235, v222
    v_fma_f32 v215, v215, v235, v223
    v_mfma_f32_16x16x32_bf16 v[162:165], v[22:25], v[134:137], 0
    v_fma_f32 v216, v216, v235, v224
    v_fma_f32 v217, v217, v235, v225
    v_mfma_f32_16x16x32_bf16 v[154:157], v[134:137], v[38:41], 0
    v_cvt_pk_bf16_f32 v214, v214, v215
    v_fma_f32 v218, v218, v235, v226
    v_mfma_f32_16x16x32_bf16 v[158:161], v[26:29], v[138:141], v[158:161]
    v_fma_f32 v219, v219, v235, v227
    v_fma_f32 v220, v220, v235, v228
    v_mfma_f32_16x16x32_bf16 v[162:165], v[30:33], v[138:141], v[162:165]
    v_fma_f32 v221, v221, v235, v229
    v_cvt_pk_bf16_f32 v215, v216, v217
    v_mfma_f32_16x16x32_bf16 v[154:157], v[138:141], v[46:49], v[154:157]
    v_cvt_pk_bf16_f32 v216, v218, v219
    v_cvt_pk_bf16_f32 v217, v220, v221
    v_mfma_f32_16x16x32_bf16 v[218:221], v[108:111], v[180:183], 0
    v_pk_max_i16 v214, v214, 0
    v_pk_max_i16 v215, v215, 0
    v_mfma_f32_16x16x32_bf16 v[234:237], v[238:241], v[180:183], 0
    v_pk_max_i16 v216, v216, 0
    v_pk_max_i16 v217, v217, 0
    v_mfma_f32_16x16x32_bf16 v[206:209], v[94:97], v[196:199], 0
    ds_write_b128 v252, v[214:217] offset:18432
    v_cvt_pk_bf16_f32 v114, v150, v151
    v_cvt_pk_bf16_f32 v115, v152, v153
    v_mfma_f32_16x16x32_bf16 v[150:153], v[134:137], v[34:37], 0
    s_add_u32 s38, s33, 26214400
    v_cvt_pk_bf16_f32 v82, v158, v159
    v_cvt_pk_bf16_f32 v83, v160, v161
    v_mfma_f32_16x16x32_bf16 v[150:153], v[138:141], v[42:45], v[150:153]
    ds_read_b128 v[134:137], v246 offset:28672
    v_cvt_pk_bf16_f32 v84, v162, v163
    v_cvt_pk_bf16_f32 v85, v164, v165
    v_mfma_f32_16x16x32_bf16 v[230:233], v[238:241], v[196:199], 0
    ds_read_b128 v[138:141], v247 offset:28672
    v_cvt_pk_bf16_f32 v116, v154, v155
    v_cvt_pk_bf16_f32 v117, v156, v157
    v_mfma_f32_16x16x32_bf16 v[214:217], v[94:97], v[180:183], 0
    s_waitcnt lgkmcnt(3)
    v_cvt_pk_bf16_f32 v102, v150, v151
    v_cvt_pk_bf16_f32 v103, v152, v153
    v_mfma_f32_16x16x32_bf16 v[178:181], v[82:85], v[166:169], v[242:245]
    s_add_u32 s39, s33, 26216448
    v_exp_f32 v190, v190
    v_mfma_f32_16x16x32_bf16 v[158:161], v[18:21], v[142:145], 0
    v_exp_f32 v191, v191
    v_mfma_f32_16x16x32_bf16 v[158:161], v[26:29], v[146:149], v[158:161]
    v_exp_f32 v192, v192
    v_mfma_f32_16x16x32_bf16 v[162:165], v[22:25], v[142:145], 0
    v_exp_f32 v193, v193
    v_mfma_f32_16x16x32_bf16 v[162:165], v[30:33], v[146:149], v[162:165]
    v_cvt_pk_bf16_f32 v190, v190, v191
    v_cvt_pk_bf16_f32 v188, v186, v187
    v_mfma_f32_16x16x32_bf16 v[154:157], v[142:145], v[38:41], 0
    s_nop 0
    v_cvt_pk_bf16_f32 v86, v158, v159
    v_cvt_pk_bf16_f32 v87, v160, v161
    v_mfma_f32_16x16x32_bf16 v[154:157], v[146:149], v[46:49], v[154:157]
    s_nop 0
    v_cvt_pk_bf16_f32 v88, v162, v163
    v_cvt_pk_bf16_f32 v89, v164, v165
    v_mfma_f32_16x16x32_bf16 v[150:153], v[142:145], v[34:37], 0
    v_cvt_pk_bf16_f32 v191, v192, v193
    v_exp_f32 v180, v180
    v_mfma_f32_16x16x32_bf16 v[182:185], v[86:89], v[166:169], v[242:245]
    ds_read_b128 v[142:145], v246 offset:30720
    v_cvt_pk_bf16_f32 v118, v154, v155
    v_cvt_pk_bf16_f32 v119, v156, v157
    v_mfma_f32_16x16x32_bf16 v[230:233], v[238:241], v[188:191], v[230:233]
    s_waitcnt lgkmcnt(3)
    s_barrier
    v_exp_f32 v181, v181
    v_mfma_f32_16x16x32_bf16 v[150:153], v[146:149], v[42:45], v[150:153]
    ds_read_b128 v[158:161], v253 offset:16384
    v_exp_f32 v182, v182
    v_mfma_f32_16x16x32_bf16 v[206:209], v[98:101], v[188:191], v[206:209]
    ds_read_b128 v[146:149], v247 offset:30720
    v_exp_f32 v183, v183
    v_mfma_f32_16x16x32_bf16 v[210:213], v[108:111], v[196:199], 0
    s_waitcnt lgkmcnt(3)
    v_exp_f32 v178, v178
    v_mfma_f32_16x16x32_bf16 v[194:197], v[74:77], v[170:173], v[242:245]
    ds_read_b128 v[162:165], v253 offset:18432
    v_cvt_pk_bf16_f32 v104, v150, v151
    v_cvt_pk_bf16_f32 v105, v152, v153
    v_mfma_f32_16x16x32_bf16 v[150:153], v[2:5], v[134:137], 0
    v_exp_f32 v179, v179
    v_mfma_f32_16x16x32_bf16 v[198:201], v[78:81], v[170:173], v[242:245]
    v_exp_f32 v184, v184
    v_mfma_f32_16x16x32_bf16 v[154:157], v[6:9], v[134:137], 0
    v_exp_f32 v185, v185
    v_mfma_f32_16x16x32_bf16 v[150:153], v[10:13], v[138:141], v[150:153]
    ds_read_b128 v[134:137], v246 offset:24576
    v_cvt_pk_bf16_f32 v181, v180, v181
    v_cvt_pk_bf16_f32 v182, v182, v183
    v_mfma_f32_16x16x32_bf16 v[154:157], v[14:17], v[138:141], v[154:157]
    v_cvt_pk_bf16_f32 v180, v178, v179
    v_cvt_pk_bf16_f32 v183, v184, v185
    v_mfma_f32_16x16x32_bf16 v[210:213], v[112:115], v[188:191], v[210:213]
    ds_read_b128 v[138:141], v247 offset:24576
    v_cvt_pk_bf16_f32 v174, v150, v151
    v_cvt_pk_bf16_f32 v175, v152, v153
    v_mfma_f32_16x16x32_bf16 v[186:189], v[82:85], v[170:173], v[242:245]
    s_waitcnt lgkmcnt(4)
    buffer_store_dwordx4 v[158:161], v249, s[12:15], s36 offen sc1
    v_mfma_f32_16x16x32_bf16 v[190:193], v[86:89], v[170:173], v[242:245]
    s_waitcnt lgkmcnt(3)
    v_cvt_pk_bf16_f32 v176, v154, v155
    v_cvt_pk_bf16_f32 v177, v156, v157
    v_mfma_f32_16x16x32_bf16 v[150:153], v[2:5], v[142:145], 0
    v_exp_f32 v196, v196
    v_mfma_f32_16x16x32_bf16 v[154:157], v[6:9], v[142:145], 0
    s_waitcnt lgkmcnt(2)
    buffer_store_dwordx4 v[162:165], v249, s[12:15], s37 offen sc1
    v_mfma_f32_16x16x32_bf16 v[150:153], v[10:13], v[146:149], v[150:153]
    ds_read_b128 v[142:145], v246 offset:26624
    v_exp_f32 v197, v197
    v_mfma_f32_16x16x32_bf16 v[154:157], v[14:17], v[146:149], v[154:157]
    v_exp_f32 v198, v198
    v_mfma_f32_16x16x32_bf16 v[158:161], v[90:93], v[166:169], v[242:245]
    ds_read_b128 v[146:149], v247 offset:26624
    v_exp_f32 v199, v199
    v_mfma_f32_16x16x32_bf16 v[230:233], v[238:241], v[180:183], v[230:233]
    v_exp_f32 v194, v194
    v_mfma_f32_16x16x32_bf16 v[206:209], v[102:105], v[180:183], v[206:209]
    v_exp_f32 v195, v195
    v_mfma_f32_16x16x32_bf16 v[210:213], v[116:119], v[180:183], v[210:213]
    s_waitcnt lgkmcnt(2)
    v_exp_f32 v160, v160
    v_mfma_f32_16x16x32_bf16 v[222:225], v[50:53], v[134:137], 0
    v_exp_f32 v200, v200
    v_mfma_f32_16x16x32_bf16 v[162:165], v[90:93], v[170:173], v[242:245]
    v_exp_f32 v201, v201
    v_mfma_f32_16x16x32_bf16 v[226:229], v[54:57], v[134:137], 0
    v_cvt_pk_bf16_f32 v197, v196, v197
    v_cvt_pk_bf16_f32 v198, v198, v199
    v_mfma_f32_16x16x32_bf16 v[222:225], v[58:61], v[138:141], v[222:225]
    ds_read_b128 v[134:137], v246 offset:28672
    v_cvt_pk_bf16_f32 v203, v160, 0
    v_cvt_pk_bf16_f32 v196, v194, v195
    v_mfma_f32_16x16x32_bf16 v[226:229], v[62:65], v[138:141], v[226:229]
    v_cvt_pk_bf16_f32 v199, v200, v201
    v_exp_f32 v188, v188
    v_mfma_f32_16x16x16_bf16 v[230:233], v[238:239], v[202:203], v[230:233]
    v_exp_f32 v189, v189
    v_exp_f32 v190, v190
    v_mfma_f32_16x16x32_bf16 v[234:237], v[238:241], v[196:199], v[234:237]
    s_waitcnt lgkmcnt(1)
    v_exp_f32 v191, v191
    v_mfma_f32_16x16x16_bf16 v[206:209], v[106:107], v[202:203], v[206:209]
    v_exp_f32 v186, v186
    v_cvt_pk_bf16_f32 v189, v188, v189
    v_mfma_f32_16x16x32_bf16 v[214:217], v[98:101], v[196:199], v[214:217]
    ds_read_b128 v[138:141], v247 offset:28672
    v_exp_f32 v187, v187
    v_mfma_f32_16x16x32_bf16 v[178:181], v[74:77], v[174:177], v[242:245]
    v_exp_f32 v192, v192
    v_mfma_f32_16x16x16_bf16 v[210:213], v[120:121], v[202:203], v[210:213]
    v_exp_f32 v193, v193
    v_cvt_pk_bf16_f32 v190, v190, v191
    v_mfma_f32_16x16x32_bf16 v[218:221], v[112:115], v[196:199], v[218:221]
    v_cvt_pk_bf16_f32 v188, v186, v187
    v_cvt_pk_bf16_f32 v191, v192, v193
    v_mfma_f32_16x16x32_bf16 v[194:197], v[66:69], v[174:177], v[242:245]
    v_rcp_f32 v231, v230
    v_mfma_f32_16x16x32_bf16 v[234:237], v[238:241], v[188:191], v[234:237]
    v_exp_f32 v164, v164
    v_mfma_f32_16x16x32_bf16 v[214:217], v[102:105], v[188:191], v[214:217]
    v_fma_f32 v206, v206, v231, v222
    v_fma_f32 v207, v207, v231, v223
    v_mfma_f32_16x16x32_bf16 v[218:221], v[116:119], v[188:191], v[218:221]
    v_fma_f32 v208, v208, v231, v224
    v_fma_f32 v209, v209, v231, v225
    v_mfma_f32_16x16x32_bf16 v[222:225], v[50:53], v[142:145], 0
    v_mov_b32 v204, 0
    v_cvt_pk_bf16_f32 v205, v164, 0
    v_mfma_f32_16x16x32_bf16 v[222:225], v[58:61], v[146:149], v[222:225]
    v_fma_f32 v210, v210, v231, v226
    v_fma_f32 v211, v211, v231, v227
    v_mfma_f32_16x16x16_bf16 v[234:237], v[238:239], v[204:205], v[234:237]
    v_fma_f32 v212, v212, v231, v228
    v_fma_f32 v213, v213, v231, v229
    v_cvt_pk_bf16_f32 v206, v206, v207
    v_mfma_f32_16x16x32_bf16 v[226:229], v[54:57], v[142:145], 0
    s_waitcnt lgkmcnt(0)
    v_cvt_pk_bf16_f32 v207, v208, v209
    v_cvt_pk_bf16_f32 v208, v210, v211
    v_mfma_f32_16x16x16_bf16 v[214:217], v[106:107], v[204:205], v[214:217]
    v_rcp_f32 v235, v234
    v_cvt_pk_bf16_f32 v209, v212, v213
    v_mfma_f32_16x16x32_bf16 v[226:229], v[62:65], v[146:149], v[226:229]
    ds_read_b128 v[142:145], v246 offset:32768
    v_pk_max_i16 v206, v206, 0
    v_pk_max_i16 v207, v207, 0
    v_mfma_f32_16x16x16_bf16 v[218:221], v[120:121], v[204:205], v[218:221]
    v_pk_max_i16 v208, v208, 0
    v_fma_f32 v214, v214, v235, v222
    v_fma_f32 v215, v215, v235, v223
    v_mfma_f32_16x16x32_bf16 v[198:201], v[70:73], v[174:177], v[242:245]
    ds_read_b128 v[146:149], v247 offset:32768
    v_fma_f32 v216, v216, v235, v224
    v_fma_f32 v217, v217, v235, v225
    v_mfma_f32_16x16x32_bf16 v[182:185], v[78:81], v[174:177], v[242:245]
    v_cvt_pk_bf16_f32 v214, v214, v215
    v_fma_f32 v218, v218, v235, v226
    v_mfma_f32_16x16x32_bf16 v[222:225], v[50:53], v[134:137], 0
    v_fma_f32 v219, v219, v235, v227
    v_fma_f32 v220, v220, v235, v228
    v_mfma_f32_16x16x32_bf16 v[186:189], v[82:85], v[174:177], v[242:245]
    v_fma_f32 v221, v221, v235, v229
    v_cvt_pk_bf16_f32 v215, v216, v217
    v_mfma_f32_16x16x32_bf16 v[226:229], v[54:57], v[134:137], 0
    v_cvt_pk_bf16_f32 v216, v218, v219
    v_cvt_pk_bf16_f32 v217, v220, v221
    v_mfma_f32_16x16x32_bf16 v[190:193], v[86:89], v[174:177], v[242:245]
    ds_read_b128 v[134:137], v246 offset:30720
    v_pk_max_i16 v209, v209, 0
    v_pk_max_i16 v214, v214, 0
    v_mfma_f32_16x16x32_bf16 v[222:225], v[58:61], v[138:141], v[222:225]
    ds_write_b128 v252, v[206:209] offset:20480
    v_pk_max_i16 v215, v215, 0
    v_pk_max_i16 v216, v216, 0
    v_mfma_f32_16x16x32_bf16 v[226:229], v[62:65], v[138:141], v[226:229]
    v_pk_max_i16 v217, v217, 0
    ds_write_b128 v252, v[214:217] offset:22528
    ds_read_b128 v[138:141], v247 offset:30720
    v_cvt_pk_bf16_f32 v166, v150, v151
    v_cvt_pk_bf16_f32 v167, v152, v153
    v_cvt_pk_bf16_f32 v168, v154, v155
    v_cvt_pk_bf16_f32 v169, v156, v157
    v_exp_f32 v196, v196
    v_exp_f32 v197, v197
    s_waitcnt lgkmcnt(4)
    v_mfma_f32_16x16x32_bf16 v[150:153], v[2:5], v[142:145], 0
    v_exp_f32 v198, v198
    v_mfma_f32_16x16x32_bf16 v[154:157], v[6:9], v[142:145], 0
    v_exp_f32 v199, v199
    v_mfma_f32_16x16x32_bf16 v[150:153], v[10:13], v[146:149], v[150:153]
    ds_read_b128 v[142:145], v246 offset:34816
    v_exp_f32 v194, v194
    v_mfma_f32_16x16x32_bf16 v[154:157], v[14:17], v[146:149], v[154:157]
    v_exp_f32 v195, v195
    ds_read_b128 v[146:149], v247 offset:34816
    v_exp_f32 v200, v200
    v_exp_f32 v201, v201
    v_cvt_pk_bf16_f32 v197, v196, v197
    v_cvt_pk_bf16_f32 v198, v198, v199
    v_cvt_pk_bf16_f32 v196, v194, v195
    v_cvt_pk_bf16_f32 v199, v200, v201
    v_exp_f32 v180, v180
    v_exp_f32 v181, v181
    v_mfma_f32_16x16x32_bf16 v[206:209], v[94:97], v[196:199], 0
    s_waitcnt lgkmcnt(2)
    v_exp_f32 v182, v182
    v_mfma_f32_16x16x32_bf16 v[210:213], v[108:111], v[196:199], 0
    v_exp_f32 v183, v183
    v_max3_u32 v0, v0, v230, v234
    v_min3_u32 v1, v1, v230, v234
    v_mfma_f32_16x16x32_bf16 v[230:233], v[238:241], v[196:199], 0
    s_barrier
    v_exp_f32 v178, v178
    v_mfma_f32_16x16x32_bf16 v[194:197], v[66:69], v[166:169], v[242:245]
    ds_read_b128 v[158:161], v253 offset:20480
    v_exp_f32 v179, v179
    v_mfma_f32_16x16x32_bf16 v[198:201], v[70:73], v[166:169], v[242:245]
    ds_read_b128 v[162:165], v253 offset:22528
    v_exp_f32 v184, v184
    v_exp_f32 v185, v185
    v_cvt_pk_bf16_f32 v181, v180, v181
    v_cvt_pk_bf16_f32 v182, v182, v183
    v_cvt_pk_bf16_f32 v180, v178, v179
    s_waitcnt lgkmcnt(2)
    v_cvt_pk_bf16_f32 v183, v184, v185
    v_exp_f32 v188, v188
    v_exp_f32 v189, v189
    v_mfma_f32_16x16x32_bf16 v[230:233], v[238:241], v[180:183], v[230:233]
    s_add_u32 s40, s33, 26218496
    v_exp_f32 v190, v190
    v_mfma_f32_16x16x32_bf16 v[206:209], v[98:101], v[180:183], v[206:209]
    s_add_u32 s41, s33, 26220544
    v_exp_f32 v191, v191
    v_mfma_f32_16x16x32_bf16 v[210:213], v[112:115], v[180:183], v[210:213]
    v_exp_f32 v186, v186
    v_mfma_f32_16x16x32_bf16 v[178:181], v[74:77], v[166:169], v[242:245]
    v_exp_f32 v187, v187
    v_mfma_f32_16x16x32_bf16 v[182:185], v[78:81], v[166:169], v[242:245]
    v_exp_f32 v192, v192
    v_exp_f32 v193, v193
    v_cvt_pk_bf16_f32 v189, v188, v189
    v_cvt_pk_bf16_f32 v190, v190, v191
    v_cvt_pk_bf16_f32 v170, v150, v151
    v_cvt_pk_bf16_f32 v171, v152, v153
    v_mfma_f32_16x16x32_bf16 v[150:153], v[122:125], v[70:73], v[242:245]
    s_waitcnt lgkmcnt(1)
    buffer_store_dwordx4 v[158:161], v249, s[12:15], s38 offen sc1
    v_cvt_pk_bf16_f32 v188, v186, v187
    v_cvt_pk_bf16_f32 v191, v192, v193
    v_mfma_f32_16x16x32_bf16 v[158:161], v[90:93], v[174:177], v[242:245]
    s_waitcnt lgkmcnt(0)
    buffer_store_dwordx4 v[162:165], v249, s[12:15], s39 offen sc1
    v_mfma_f32_16x16x32_bf16 v[230:233], v[238:241], v[188:191], v[230:233]
    v_cvt_pk_bf16_f32 v172, v154, v155
    v_cvt_pk_bf16_f32 v173, v156, v157
    v_mfma_f32_16x16x32_bf16 v[162:165], v[122:125], v[66:69], v[242:245]
    v_exp_f32 v196, v196
    v_mfma_f32_16x16x32_bf16 v[154:157], v[122:125], v[74:77], v[242:245]
    v_exp_f32 v160, v160
    v_mfma_f32_16x16x32_bf16 v[206:209], v[102:105], v[188:191], v[206:209]
    v_cvt_pk_bf16_f32 v203, v160, 0
    v_exp_f32 v197, v197
    v_mfma_f32_16x16x32_bf16 v[210:213], v[116:119], v[188:191], v[210:213]
    v_exp_f32 v198, v198
    v_mfma_f32_16x16x32_bf16 v[158:161], v[122:125], v[78:81], v[242:245]
    v_exp_f32 v199, v199
    v_mfma_f32_16x16x16_bf16 v[230:233], v[238:239], v[202:203], v[230:233]
    v_exp_f32 v194, v194
    v_cvt_pk_bf16_f32 v197, v196, v197
    v_mfma_f32_16x16x16_bf16 v[206:209], v[106:107], v[202:203], v[206:209]
    v_exp_f32 v195, v195
    v_cvt_pk_bf16_f32 v198, v198, v199
    v_mfma_f32_16x16x16_bf16 v[210:213], v[120:121], v[202:203], v[210:213]
    v_exp_f32 v200, v200
    v_cvt_pk_bf16_f32 v196, v194, v195
    v_exp_f32 v201, v201
    v_exp_f32 v186, v164
    v_mfma_f32_16x16x32_bf16 v[162:165], v[122:125], v[82:85], v[242:245]
    v_exp_f32 v187, v152
    v_mfma_f32_16x16x32_bf16 v[150:153], v[122:125], v[86:89], v[242:245]
    v_exp_f32 v188, v156
    v_mfma_f32_16x16x32_bf16 v[154:157], v[122:125], v[90:93], v[242:245]
    v_cvt_pk_bf16_f32 v199, v200, v201
    v_cvt_pk_bf16_f32 v186, v186, v187
    v_exp_f32 v189, v160
    v_mfma_f32_16x16x32_bf16 v[214:217], v[94:97], v[196:199], 0
    ds_write_b16 v250, v186 offset:0
    v_rcp_f32 v231, v230
    v_mfma_f32_16x16x32_bf16 v[218:221], v[108:111], v[196:199], 0
    ds_write_b16_d16_hi v250, v186 offset:32
    v_exp_f32 v190, v164
    v_mfma_f32_16x16x32_bf16 v[234:237], v[238:241], v[196:199], 0
    v_exp_f32 v191, v152
    v_mfma_f32_16x16x32_bf16 v[194:197], v[82:85], v[166:169], v[242:245]
    v_cvt_pk_bf16_f32 v188, v188, v189
    v_fma_f32 v206, v206, v231, v222
    v_mfma_f32_16x16x32_bf16 v[198:201], v[86:89], v[166:169], v[242:245]
    ds_write_b16 v250, v188 offset:64
    v_fma_f32 v207, v207, v231, v223
    v_fma_f32 v208, v208, v231, v224
    v_mfma_f32_16x16x32_bf16 v[158:161], v[2:5], v[142:145], 0
    ds_write_b16_d16_hi v250, v188 offset:96
    v_fma_f32 v209, v209, v231, v225
    v_fma_f32 v210, v210, v231, v226
    v_mfma_f32_16x16x32_bf16 v[222:225], v[50:53], v[134:137], 0
    v_fma_f32 v211, v211, v231, v227
    v_fma_f32 v212, v212, v231, v228
    v_mfma_f32_16x16x32_bf16 v[162:165], v[6:9], v[142:145], 0
    v_fma_f32 v213, v213, v231, v229
    v_cvt_pk_bf16_f32 v190, v190, v191
    v_mfma_f32_16x16x32_bf16 v[226:229], v[54:57], v[134:137], 0
    ds_write_b16 v250, v190 offset:128
    v_exp_f32 v180, v180
    v_mfma_f32_16x16x32_bf16 v[222:225], v[58:61], v[138:141], v[222:225]
    ds_write_b16_d16_hi v250, v190 offset:160
    v_exp_f32 v181, v181
    v_mfma_f32_16x16x32_bf16 v[226:229], v[62:65], v[138:141], v[226:229]
    v_exp_f32 v182, v182
    v_mfma_f32_16x16x32_bf16 v[150:153], v[90:93], v[166:169], v[242:245]
    v_exp_f32 v183, v183
    v_mfma_f32_16x16x32_bf16 v[158:161], v[10:13], v[146:149], v[158:161]
    v_exp_f32 v192, v156
    v_mfma_f32_16x16x32_bf16 v[162:165], v[14:17], v[146:149], v[162:165]
    v_exp_f32 v178, v178
    v_mfma_f32_16x16x32_bf16 v[186:189], v[74:77], v[170:173], v[242:245]
    v_exp_f32 v179, v179
    v_exp_f32 v184, v184
    v_exp_f32 v185, v185
    v_cvt_pk_bf16_f32 v181, v180, v181
    v_cvt_pk_bf16_f32 v182, v182, v183
    v_cndmask_b32 v192, 0, v192, s[60:61]
    v_cvt_pk_bf16_f32 v180, v178, v179
    v_cvt_pk_bf16_f32 v183, v184, v185
    v_cvt_pk_bf16_f32 v192, v192, 0
    v_exp_f32 v196, v196
    v_mfma_f32_16x16x32_bf16 v[234:237], v[238:241], v[180:183], v[234:237]
    ds_write_b16 v250, v192 offset:192
    v_exp_f32 v197, v197
    v_mfma_f32_16x16x32_bf16 v[214:217], v[98:101], v[180:183], v[214:217]
    ds_read2_b64 v[134:137], v251 offset0:0 offset1:4
    v_exp_f32 v198, v198
    v_mfma_f32_16x16x32_bf16 v[218:221], v[112:115], v[180:183], v[218:221]
    ds_read2_b64 v[138:141], v251 offset0:8 offset1:12
    v_exp_f32 v199, v199
    v_mfma_f32_16x16x32_bf16 v[178:181], v[66:69], v[170:173], v[242:245]
    ds_read2_b64 v[142:145], v251 offset0:16 offset1:20
    v_exp_f32 v194, v194
    v_mfma_f32_16x16x32_bf16 v[182:185], v[70:73], v[170:173], v[242:245]
    ds_read_b64 v[146:147], v251 offset:192
    v_exp_f32 v195, v195
    v_mfma_f32_16x16x32_bf16 v[190:193], v[78:81], v[170:173], v[242:245]
    v_exp_f32 v200, v200
    v_exp_f32 v201, v201
    v_cvt_pk_bf16_f32 v197, v196, v197
    v_cvt_pk_bf16_f32 v198, v198, v199
    v_cvt_pk_bf16_f32 v196, v194, v195
    v_cvt_pk_bf16_f32 v199, v200, v201
    v_exp_f32 v152, v152
    v_cvt_pk_bf16_f32 v206, v206, v207
    v_mfma_f32_16x16x32_bf16 v[234:237], v[238:241], v[196:199], v[234:237]
    v_cvt_pk_bf16_f32 v205, v152, 0
    v_cvt_pk_bf16_f32 v207, v208, v209
    v_mfma_f32_16x16x32_bf16 v[214:217], v[102:105], v[196:199], v[214:217]
    v_cvt_pk_bf16_f32 v208, v210, v211
    v_cvt_pk_bf16_f32 v209, v212, v213
    v_mfma_f32_16x16x32_bf16 v[218:221], v[116:119], v[196:199], v[218:221]
    v_pk_max_i16 v206, v206, 0
    v_pk_max_i16 v207, v207, 0
    v_mfma_f32_16x16x16_bf16 v[234:237], v[238:239], v[204:205], v[234:237]
    v_pk_max_i16 v208, v208, 0
    v_pk_max_i16 v209, v209, 0
    v_cvt_pk_bf16_f32 v174, v158, v159
    v_mfma_f32_16x16x16_bf16 v[214:217], v[106:107], v[204:205], v[214:217]
    v_cvt_pk_bf16_f32 v175, v160, v161
    ds_write_b128 v252, v[206:209] offset:24576
    v_cvt_pk_bf16_f32 v176, v162, v163
    v_mfma_f32_16x16x16_bf16 v[218:221], v[120:121], v[204:205], v[218:221]
    v_rcp_f32 v235, v234
    v_max3_u32 v0, v0, v230, v234
    v_mfma_f32_16x16x32_bf16 v[194:197], v[82:85], v[170:173], v[242:245]
    s_waitcnt lgkmcnt(1)
    v_fma_f32 v214, v214, v235, v222
    v_fma_f32 v215, v215, v235, v223
    v_mfma_f32_16x16x32_bf16 v[206:209], v[94:97], v[134:137], 0
    v_fma_f32 v216, v216, v235, v224
    v_fma_f32 v217, v217, v235, v225
    v_mfma_f32_16x16x32_bf16 v[210:213], v[108:111], v[134:137], 0
    v_cvt_pk_bf16_f32 v214, v214, v215
    v_fma_f32 v218, v218, v235, v226
    v_mfma_f32_16x16x32_bf16 v[206:209], v[98:101], v[138:141], v[206:209]
    v_fma_f32 v219, v219, v235, v227
    v_fma_f32 v220, v220, v235, v228
    v_mfma_f32_16x16x32_bf16 v[210:213], v[112:115], v[138:141], v[210:213]
    v_fma_f32 v221, v221, v235, v229
    v_cvt_pk_bf16_f32 v215, v216, v217
    v_mfma_f32_16x16x32_bf16 v[206:209], v[102:105], v[142:145], v[206:209]
    v_cvt_pk_bf16_f32 v216, v218, v219
    v_cvt_pk_bf16_f32 v217, v220, v221
    v_mfma_f32_16x16x32_bf16 v[210:213], v[116:119], v[142:145], v[210:213]
    v_pk_max_i16 v214, v214, 0
    v_pk_max_i16 v215, v215, 0
    v_mfma_f32_16x16x32_bf16 v[198:201], v[86:89], v[170:173], v[242:245]
    v_pk_max_i16 v216, v216, 0
    v_pk_max_i16 v217, v217, 0
    v_mfma_f32_16x16x16_bf16 v[206:209], v[106:107], v[146:147], v[206:209]
    v_min3_u32 v1, v1, v230, v234
    ds_write_b128 v252, v[214:217] offset:26624
    v_cvt_pk_bf16_f32 v177, v164, v165
    v_mfma_f32_16x16x32_bf16 v[230:233], v[238:241], v[134:137], 0
    v_exp_f32 v180, v180
    v_mfma_f32_16x16x32_bf16 v[230:233], v[238:241], v[138:141], v[230:233]
    ds_read_b128 v[134:137], v246 offset:32768
    ds_read_b128 v[138:141], v247 offset:32768
    v_exp_f32 v181, v181
    v_mfma_f32_16x16x32_bf16 v[230:233], v[238:241], v[142:145], v[230:233]
    v_exp_f32 v182, v182
    v_mfma_f32_16x16x16_bf16 v[210:213], v[120:121], v[146:147], v[210:213]
    v_exp_f32 v183, v183
    v_cvt_pk_bf16_f32 v181, v180, v181
    v_mfma_f32_16x16x32_bf16 v[162:165], v[90:93], v[170:173], v[242:245]
    v_exp_f32 v178, v178
    v_mfma_f32_16x16x16_bf16 v[230:233], v[238:239], v[146:147], v[230:233]
    v_exp_f32 v179, v179
    v_cvt_pk_bf16_f32 v182, v182, v183
    v_exp_f32 v184, v184
    v_exp_f32 v185, v185
    v_cvt_pk_bf16_f32 v180, v178, v179
    v_cvt_pk_bf16_f32 v183, v184, v185
    v_exp_f32 v164, v164
    v_exp_f32 v188, v188
    v_mfma_f32_16x16x32_bf16 v[214:217], v[94:97], v[180:183], 0
    v_cvt_pk_bf16_f32 v203, v164, 0
    v_exp_f32 v189, v189
    v_mfma_f32_16x16x32_bf16 v[218:221], v[108:111], v[180:183], 0
    v_exp_f32 v190, v190
    v_mfma_f32_16x16x32_bf16 v[234:237], v[238:241], v[180:183], 0
    v_exp_f32 v191, v191
    v_mfma_f32_16x16x32_bf16 v[178:181], v[66:69], v[174:177], v[242:245]
    s_waitcnt lgkmcnt(0)
    s_barrier
    ds_read_b128 v[154:157], v253 offset:24576
    v_mfma_f32_16x16x32_bf16 v[222:225], v[50:53], v[134:137], 0
    ds_read_b128 v[158:161], v253 offset:26624
    v_exp_f32 v186, v186
    v_mfma_f32_16x16x32_bf16 v[226:229], v[54:57], v[134:137], 0
    v_exp_f32 v187, v187
    v_mfma_f32_16x16x32_bf16 v[222:225], v[58:61], v[138:141], v[222:225]
    v_exp_f32 v192, v192
    v_mfma_f32_16x16x32_bf16 v[226:229], v[62:65], v[138:141], v[226:229]
    v_exp_f32 v193, v193
    v_mfma_f32_16x16x32_bf16 v[182:185], v[70:73], v[174:177], v[242:245]
    v_cvt_pk_bf16_f32 v189, v188, v189
    v_cvt_pk_bf16_f32 v190, v190, v191
    v_cvt_pk_bf16_f32 v188, v186, v187
    v_cvt_pk_bf16_f32 v191, v192, v193
    v_exp_f32 v196, v196
    v_exp_f32 v197, v197
    v_mfma_f32_16x16x32_bf16 v[234:237], v[238:241], v[188:191], v[234:237]
    v_exp_f32 v198, v198
    v_mfma_f32_16x16x32_bf16 v[214:217], v[98:101], v[188:191], v[214:217]
    v_exp_f32 v199, v199
    v_mfma_f32_16x16x32_bf16 v[218:221], v[112:115], v[188:191], v[218:221]
    v_exp_f32 v194, v194
    v_mfma_f32_16x16x32_bf16 v[186:189], v[74:77], v[174:177], v[242:245]
    s_waitcnt lgkmcnt(1)
    buffer_store_dwordx4 v[154:157], v249, s[12:15], s40 offen sc1
    v_mfma_f32_16x16x32_bf16 v[190:193], v[78:81], v[174:177], v[242:245]
    s_waitcnt lgkmcnt(0)
    buffer_store_dwordx4 v[158:161], v249, s[12:15], s41 offen sc1
    s_waitcnt vmcnt(6)
    s_barrier
    s_setprio 0
    ds_read_b128 v[142:145], v246 offset:0
    ds_read_b128 v[146:149], v247 offset:0
    ds_read_b128 v[134:137], v246 offset:2048
    ds_read_b128 v[138:141], v247 offset:2048
    v_exp_f32 v195, v195
    v_exp_f32 v200, v200
    v_exp_f32 v201, v201
    v_exp_f32 v180, v180
    v_exp_f32 v181, v181
    v_exp_f32 v182, v182
    v_exp_f32 v183, v183
    v_rcp_f32 v231, v230
    v_cvt_pk_bf16_f32 v197, v196, v197
    v_cvt_pk_bf16_f32 v198, v198, v199
    v_exp_f32 v178, v178
    v_exp_f32 v179, v179
    v_exp_f32 v184, v184
    v_exp_f32 v185, v185
    v_cvt_pk_bf16_f32 v196, v194, v195
    v_cvt_pk_bf16_f32 v199, v200, v201
    v_cvt_pk_bf16_f32 v181, v180, v181
    v_cvt_pk_bf16_f32 v182, v182, v183
    v_mfma_f32_16x16x32_bf16 v[234:237], v[238:241], v[196:199], v[234:237]
    v_cndmask_b32 v231, 0, v231, s[60:61]
    v_cvt_pk_bf16_f32 v180, v178, v179
    v_mfma_f32_16x16x32_bf16 v[214:217], v[102:105], v[196:199], v[214:217]
    v_cvt_pk_bf16_f32 v183, v184, v185
    v_fma_f32 v126, v206, v231, v126
    v_mfma_f32_16x16x32_bf16 v[218:221], v[116:119], v[196:199], v[218:221]
    s_waitcnt lgkmcnt(2)
    v_fma_f32 v127, v207, v231, v127
    v_fma_f32 v128, v208, v231, v128
    v_mfma_f32_16x16x32_bf16 v[150:153], v[2:5], v[142:145], 0
    s_waitcnt lgkmcnt(0)
    v_fma_f32 v129, v209, v231, v129
    v_fma_f32 v130, v210, v231, v130
    v_mfma_f32_16x16x32_bf16 v[154:157], v[6:9], v[142:145], 0
    v_fma_f32 v131, v211, v231, v131
    v_fma_f32 v132, v212, v231, v132
    v_mfma_f32_16x16x32_bf16 v[150:153], v[10:13], v[146:149], v[150:153]
    v_fma_f32 v133, v213, v231, v133
    v_exp_f32 v188, v188
    v_mfma_f32_16x16x32_bf16 v[154:157], v[14:17], v[146:149], v[154:157]
    v_exp_f32 v189, v189
    v_mfma_f32_16x16x32_bf16 v[158:161], v[18:21], v[142:145], 0
    v_exp_f32 v190, v190
    v_mfma_f32_16x16x16_bf16 v[234:237], v[238:239], v[202:203], v[234:237]
    v_exp_f32 v191, v191
    v_cvt_pk_bf16_f32 v166, v150, v151
    v_mfma_f32_16x16x32_bf16 v[162:165], v[22:25], v[142:145], 0
    v_cvt_pk_bf16_f32 v167, v152, v153
    v_cvt_pk_bf16_f32 v168, v154, v155
    v_mfma_f32_16x16x32_bf16 v[194:197], v[82:85], v[174:177], v[242:245]
    v_cvt_pk_bf16_f32 v169, v156, v157
    v_cvt_pk_bf16_f32 v189, v188, v189
    v_mfma_f32_16x16x32_bf16 v[158:161], v[26:29], v[146:149], v[158:161]
    v_rcp_f32 v235, v234
    v_mfma_f32_16x16x32_bf16 v[162:165], v[30:33], v[146:149], v[162:165]
    v_max3_u32 v0, v0, v230, v234
    v_min3_u32 v1, v1, v230, v234
    v_mfma_f32_16x16x32_bf16 v[150:153], v[142:145], v[34:37], 0
    v_exp_f32 v186, v186
    v_mfma_f32_16x16x32_bf16 v[154:157], v[142:145], v[38:41], 0
    s_nop 0
    v_cvt_pk_bf16_f32 v66, v158, v159
    v_cvt_pk_bf16_f32 v67, v160, v161
    v_mfma_f32_16x16x32_bf16 v[150:153], v[146:149], v[42:45], v[150:153]
    ds_read_b128 v[142:145], v246 offset:34816
    v_cvt_pk_bf16_f32 v68, v162, v163
    v_cvt_pk_bf16_f32 v69, v164, v165
    v_mfma_f32_16x16x32_bf16 v[198:201], v[86:89], v[174:177], v[242:245]
    v_exp_f32 v187, v187
    v_mfma_f32_16x16x32_bf16 v[154:157], v[146:149], v[46:49], v[154:157]
    v_exp_f32 v192, v192
    v_mfma_f32_16x16x32_bf16 v[158:161], v[2:5], v[134:137], 0
    ds_read_b128 v[146:149], v247 offset:34816
    v_exp_f32 v193, v193
    v_mfma_f32_16x16x32_bf16 v[162:165], v[6:9], v[134:137], 0
    v_cvt_pk_bf16_f32 v190, v190, v191
    v_cvt_pk_bf16_f32 v188, v186, v187
    v_mfma_f32_16x16x32_bf16 v[158:161], v[10:13], v[138:141], v[158:161]
    v_cvt_pk_bf16_f32 v191, v192, v193
    v_exp_f32 v196, v196
    v_mfma_f32_16x16x32_bf16 v[162:165], v[14:17], v[138:141], v[162:165]
    v_exp_f32 v197, v197
    v_mfma_f32_16x16x32_bf16 v[206:209], v[94:97], v[180:183], 0
    v_cvt_pk_bf16_f32 v94, v150, v151
    v_cvt_pk_bf16_f32 v95, v152, v153
    v_mfma_f32_16x16x32_bf16 v[210:213], v[108:111], v[180:183], 0
    v_cvt_pk_bf16_f32 v108, v154, v155
    v_cvt_pk_bf16_f32 v109, v156, v157
    v_mfma_f32_16x16x32_bf16 v[150:153], v[18:21], v[134:137], 0
    v_cvt_pk_bf16_f32 v170, v158, v159
    v_cvt_pk_bf16_f32 v171, v160, v161
    v_mfma_f32_16x16x16_bf16 v[214:217], v[106:107], v[202:203], v[214:217]
    v_cvt_pk_bf16_f32 v172, v162, v163
    v_cvt_pk_bf16_f32 v173, v164, v165
    v_cvt_pk_bf16_f32 v197, v196, v197
    v_mfma_f32_16x16x32_bf16 v[154:157], v[22:25], v[134:137], 0
    v_exp_f32 v198, v198
    v_mfma_f32_16x16x16_bf16 v[218:221], v[120:121], v[202:203], v[218:221]
    v_exp_f32 v199, v199
    v_exp_f32 v194, v194
    v_mfma_f32_16x16x32_bf16 v[206:209], v[98:101], v[188:191], v[206:209]
    s_waitcnt lgkmcnt(0)
    v_fma_f32 v214, v214, v235, v222
    v_fma_f32 v215, v215, v235, v223
    v_mfma_f32_16x16x32_bf16 v[150:153], v[26:29], v[138:141], v[150:153]
    v_fma_f32 v216, v216, v235, v224
    v_fma_f32 v217, v217, v235, v225
    v_mfma_f32_16x16x32_bf16 v[222:225], v[50:53], v[142:145], 0
    v_fma_f32 v218, v218, v235, v226
    v_fma_f32 v219, v219, v235, v227
    v_mfma_f32_16x16x32_bf16 v[222:225], v[58:61], v[146:149], v[222:225]
    v_fma_f32 v220, v220, v235, v228
    v_fma_f32 v221, v221, v235, v229
    v_mfma_f32_16x16x32_bf16 v[226:229], v[54:57], v[142:145], 0
    v_cvt_pk_bf16_f32 v70, v150, v151
    v_cvt_pk_bf16_f32 v71, v152, v153
    v_mfma_f32_16x16x32_bf16 v[226:229], v[62:65], v[146:149], v[226:229]
    ds_read_b128 v[142:145], v246 offset:6144
    v_exp_f32 v195, v195
    v_mfma_f32_16x16x32_bf16 v[154:157], v[30:33], v[138:141], v[154:157]
    ds_read_b128 v[146:149], v247 offset:6144
    v_exp_f32 v200, v200
    v_mfma_f32_16x16x32_bf16 v[210:213], v[112:115], v[188:191], v[210:213]
    v_exp_f32 v201, v201
    v_mfma_f32_16x16x32_bf16 v[230:233], v[238:241], v[180:183], 0
    v_cvt_pk_bf16_f32 v198, v198, v199
    v_cvt_pk_bf16_f32 v196, v194, v195
    v_mfma_f32_16x16x32_bf16 v[178:181], v[66:69], v[166:169], v[242:245]
    v_cvt_pk_bf16_f32 v199, v200, v201
    v_cvt_pk_bf16_f32 v72, v154, v155
    v_mfma_f32_16x16x32_bf16 v[230:233], v[238:241], v[188:191], v[230:233]
    v_cvt_pk_bf16_f32 v73, v156, v157
    v_cvt_pk_bf16_f32 v214, v214, v215
    v_mfma_f32_16x16x32_bf16 v[186:189], v[66:69], v[170:173], v[242:245]
    v_cvt_pk_bf16_f32 v215, v216, v217
    v_cvt_pk_bf16_f32 v216, v218, v219
    v_mfma_f32_16x16x32_bf16 v[158:161], v[134:137], v[34:37], 0
    v_cvt_pk_bf16_f32 v217, v220, v221
    v_pk_max_i16 v214, v214, 0
    v_mfma_f32_16x16x32_bf16 v[162:165], v[134:137], v[38:41], 0
    v_pk_max_i16 v215, v215, 0
    ds_read_b128 v[134:137], v246 offset:4096
    v_mfma_f32_16x16x32_bf16 v[158:161], v[138:141], v[42:45], v[158:161]
    v_pk_max_i16 v216, v216, 0
    v_pk_max_i16 v217, v217, 0
    v_mfma_f32_16x16x32_bf16 v[162:165], v[138:141], v[46:49], v[162:165]
    ds_write_b128 v252, v[214:217] offset:28672
    ds_read_b128 v[138:141], v247 offset:4096
    v_exp_f32 v188, v188
    v_mfma_f32_16x16x32_bf16 v[230:233], v[238:241], v[196:199], v[230:233]
    s_waitcnt lgkmcnt(3)
    v_cvt_pk_bf16_f32 v96, v158, v159
    v_cvt_pk_bf16_f32 v97, v160, v161
    v_mfma_f32_16x16x32_bf16 v[206:209], v[102:105], v[196:199], v[206:209]
    s_add_u32 s42, s33, 26222592
    v_cvt_pk_bf16_f32 v110, v162, v163
    v_cvt_pk_bf16_f32 v111, v164, v165
    v_mfma_f32_16x16x32_bf16 v[190:193], v[70:73], v[170:173], v[242:245]
    s_add_u32 s43, s33, 26224640
    v_exp_f32 v189, v189
    v_mfma_f32_16x16x32_bf16 v[210:213], v[116:119], v[196:199], v[210:213]
    v_exp_f32 v186, v186
    v_mfma_f32_16x16x32_bf16 v[182:185], v[70:73], v[166:169], v[242:245]
    v_exp_f32 v187, v187
    v_cvt_pk_bf16_f32 v189, v188, v189
    v_cvt_pk_bf16_f32 v188, v186, v187
    v_exp_f32 v190, v190
    v_exp_f32 v191, v191
    v_exp_f32 v192, v192
    v_exp_f32 v193, v193
    v_cvt_pk_bf16_f32 v190, v190, v191
    v_cvt_pk_bf16_f32 v191, v192, v193
    v_exp_f32 v180, v180
    v_exp_f32 v181, v181
    v_exp_f32 v182, v182
    s_waitcnt lgkmcnt(0)
    v_mfma_f32_16x16x32_bf16 v[150:153], v[18:21], v[134:137], 0
    v_exp_f32 v183, v183
    v_mfma_f32_16x16x32_bf16 v[150:153], v[26:29], v[138:141], v[150:153]
    v_exp_f32 v178, v178
    v_mfma_f32_16x16x32_bf16 v[154:157], v[22:25], v[134:137], 0
    v_exp_f32 v179, v179
    v_mfma_f32_16x16x32_bf16 v[154:157], v[30:33], v[138:141], v[154:157]
    v_exp_f32 v184, v184
    v_mfma_f32_16x16x32_bf16 v[158:161], v[134:137], v[34:37], 0
    v_exp_f32 v185, v185
    v_mfma_f32_16x16x32_bf16 v[158:161], v[138:141], v[42:45], v[158:161]
    v_cvt_pk_bf16_f32 v74, v150, v151
    v_cvt_pk_bf16_f32 v75, v152, v153
    v_mfma_f32_16x16x32_bf16 v[150:153], v[18:21], v[142:145], 0
    s_nop 0
    v_cvt_pk_bf16_f32 v76, v154, v155
    v_cvt_pk_bf16_f32 v77, v156, v157
    v_mfma_f32_16x16x32_bf16 v[150:153], v[26:29], v[146:149], v[150:153]
    s_nop 0
    v_cvt_pk_bf16_f32 v98, v158, v159
    v_cvt_pk_bf16_f32 v99, v160, v161
    v_mfma_f32_16x16x32_bf16 v[194:197], v[74:77], v[166:169], v[242:245]
    v_cvt_pk_bf16_f32 v181, v180, v181
    v_cvt_pk_bf16_f32 v182, v182, v183
    v_mfma_f32_16x16x32_bf16 v[162:165], v[134:137], v[38:41], 0
    s_nop 0
    v_cvt_pk_bf16_f32 v78, v150, v151
    v_cvt_pk_bf16_f32 v79, v152, v153
    v_mfma_f32_16x16x32_bf16 v[150:153], v[90:93], v[174:177], v[242:245]
    ds_read_b128 v[134:137], v246 offset:8192
    v_cvt_pk_bf16_f32 v180, v178, v179
    v_cvt_pk_bf16_f32 v183, v184, v185
    v_mfma_f32_16x16x32_bf16 v[162:165], v[138:141], v[46:49], v[162:165]
    v_exp_f32 v196, v196
    v_mfma_f32_16x16x32_bf16 v[234:237], v[238:241], v[180:183], 0
    ds_read_b128 v[138:141], v247 offset:8192
    v_exp_f32 v197, v197
    v_mfma_f32_16x16x32_bf16 v[214:217], v[94:97], v[180:183], 0
    v_exp_f32 v152, v152
    v_mfma_f32_16x16x32_bf16 v[154:157], v[22:25], v[142:145], 0
    v_cvt_pk_bf16_f32 v205, v152, 0
    v_cvt_pk_bf16_f32 v112, v162, v163
    v_mfma_f32_16x16x32_bf16 v[154:157], v[30:33], v[146:149], v[154:157]
    v_cvt_pk_bf16_f32 v113, v164, v165
    v_cvt_pk_bf16_f32 v197, v196, v197
    v_mfma_f32_16x16x16_bf16 v[230:233], v[238:239], v[204:205], v[230:233]
    v_exp_f32 v194, v194
    v_exp_f32 v195, v195
    v_mfma_f32_16x16x16_bf16 v[206:209], v[106:107], v[204:205], v[206:209]
    v_cvt_pk_bf16_f32 v196, v194, v195
    s_nop 0
    v_cvt_pk_bf16_f32 v80, v154, v155
    v_mfma_f32_16x16x16_bf16 v[210:213], v[120:121], v[204:205], v[210:213]
    v_cvt_pk_bf16_f32 v81, v156, v157
    v_rcp_f32 v231, v230
    v_mfma_f32_16x16x32_bf16 v[158:161], v[142:145], v[34:37], 0
    s_nop 0
    v_fma_f32 v206, v206, v231, v222
    v_fma_f32 v207, v207, v231, v223
    v_mfma_f32_16x16x32_bf16 v[198:201], v[78:81], v[166:169], v[242:245]
    v_fma_f32 v208, v208, v231, v224
    v_fma_f32 v209, v209, v231, v225
    v_mfma_f32_16x16x32_bf16 v[158:161], v[146:149], v[42:45], v[158:161]
    v_cvt_pk_bf16_f32 v206, v206, v207
    v_fma_f32 v210, v210, v231, v226
    v_mfma_f32_16x16x32_bf16 v[162:165], v[142:145], v[38:41], 0
    s_waitcnt lgkmcnt(0)
    v_fma_f32 v211, v211, v231, v227
    v_fma_f32 v212, v212, v231, v228
    v_mfma_f32_16x16x32_bf16 v[162:165], v[146:149], v[46:49], v[162:165]
    ds_read_b128 v[142:145], v246 offset:10240
    v_fma_f32 v213, v213, v231, v229
    v_cvt_pk_bf16_f32 v207, v208, v209
    v_mfma_f32_16x16x32_bf16 v[154:157], v[18:21], v[134:137], 0
    ds_read_b128 v[146:149], v247 offset:10240
    v_cvt_pk_bf16_f32 v208, v210, v211
    v_cvt_pk_bf16_f32 v209, v212, v213
    v_mfma_f32_16x16x32_bf16 v[150:153], v[134:137], v[38:41], 0
    v_pk_max_i16 v206, v206, 0
    v_pk_max_i16 v207, v207, 0
    v_mfma_f32_16x16x32_bf16 v[154:157], v[26:29], v[138:141], v[154:157]
    v_pk_max_i16 v208, v208, 0
    v_pk_max_i16 v209, v209, 0
    v_mfma_f32_16x16x32_bf16 v[150:153], v[138:141], v[46:49], v[150:153]
    ds_write_b128 v252, v[206:209] offset:30720
    v_cvt_pk_bf16_f32 v100, v158, v159
    v_cvt_pk_bf16_f32 v101, v160, v161
    v_mfma_f32_16x16x32_bf16 v[230:233], v[238:241], v[188:191], 0
    v_cvt_pk_bf16_f32 v114, v162, v163
    v_cvt_pk_bf16_f32 v115, v164, v165
    v_mfma_f32_16x16x32_bf16 v[206:209], v[94:97], v[188:191], 0
    s_add_u32 s36, s33, 39321600
    v_cvt_pk_bf16_f32 v82, v154, v155
    v_cvt_pk_bf16_f32 v83, v156, v157
    v_mfma_f32_16x16x32_bf16 v[158:161], v[22:25], v[134:137], 0
    s_add_u32 s37, s33, 39323648
    v_cvt_pk_bf16_f32 v116, v150, v151
    v_cvt_pk_bf16_f32 v117, v152, v153
    v_mfma_f32_16x16x32_bf16 v[158:161], v[30:33], v[138:141], v[158:161]
    v_exp_f32 v198, v198
    v_mfma_f32_16x16x32_bf16 v[162:165], v[134:137], v[34:37], 0
    v_exp_f32 v199, v199
    v_mfma_f32_16x16x32_bf16 v[162:165], v[138:141], v[42:45], v[162:165]
    ds_read_b128 v[134:137], v246 offset:4096
    ds_read_b128 v[138:141], v247 offset:4096
    v_cvt_pk_bf16_f32 v198, v198, v199
    v_mfma_f32_16x16x32_bf16 v[210:213], v[108:111], v[188:191], 0
    s_waitcnt lgkmcnt(3)
    v_cvt_pk_bf16_f32 v84, v158, v159
    v_cvt_pk_bf16_f32 v85, v160, v161
    v_mfma_f32_16x16x32_bf16 v[154:157], v[18:21], v[142:145], 0
    v_cvt_pk_bf16_f32 v102, v162, v163
    v_cvt_pk_bf16_f32 v103, v164, v165
    v_mfma_f32_16x16x32_bf16 v[186:189], v[82:85], v[166:169], v[242:245]
    v_exp_f32 v200, v200
    v_mfma_f32_16x16x32_bf16 v[154:157], v[26:29], v[146:149], v[154:157]
    v_exp_f32 v201, v201
    v_mfma_f32_16x16x32_bf16 v[150:153], v[142:145], v[38:41], 0
    v_cvt_pk_bf16_f32 v199, v200, v201
    v_mfma_f32_16x16x32_bf16 v[158:161], v[22:25], v[142:145], 0
    s_waitcnt lgkmcnt(2)
    s_barrier
    v_mfma_f32_16x16x32_bf16 v[234:237], v[238:241], v[196:199], v[234:237]
    v_exp_f32 v188, v188
    v_mfma_f32_16x16x32_bf16 v[214:217], v[98:101], v[196:199], v[214:217]
    v_cvt_pk_bf16_f32 v86, v154, v155
    v_cvt_pk_bf16_f32 v87, v156, v157
    v_mfma_f32_16x16x32_bf16 v[150:153], v[146:149], v[46:49], v[150:153]
    ds_read_b128 v[154:157], v253 offset:28672
    v_exp_f32 v189, v189
    v_mfma_f32_16x16x32_bf16 v[158:161], v[30:33], v[146:149], v[158:161]
    v_exp_f32 v186, v186
    v_mfma_f32_16x16x32_bf16 v[162:165], v[142:145], v[34:37], 0
    s_waitcnt lgkmcnt(1)
    v_exp_f32 v187, v187
    v_mfma_f32_16x16x32_bf16 v[162:165], v[146:149], v[42:45], v[162:165]
    ds_read_b128 v[142:145], v246 offset:6144
    v_cvt_pk_bf16_f32 v118, v150, v151
    v_cvt_pk_bf16_f32 v119, v152, v153
    v_mfma_f32_16x16x32_bf16 v[150:153], v[6:9], v[134:137], 0
    ds_read_b128 v[146:149], v247 offset:6144
    v_cvt_pk_bf16_f32 v88, v158, v159
    v_cvt_pk_bf16_f32 v89, v160, v161
    v_mfma_f32_16x16x32_bf16 v[150:153], v[14:17], v[138:141], v[150:153]
    ds_read_b128 v[158:161], v253 offset:30720
    v_cvt_pk_bf16_f32 v104, v162, v163
    v_cvt_pk_bf16_f32 v105, v164, v165
    v_mfma_f32_16x16x32_bf16 v[190:193], v[86:89], v[166:169], v[242:245]
    v_cvt_pk_bf16_f32 v189, v188, v189
    v_cvt_pk_bf16_f32 v188, v186, v187
    v_mfma_f32_16x16x32_bf16 v[162:165], v[2:5], v[134:137], 0
    s_nop 0
    v_cvt_pk_bf16_f32 v176, v150, v151
    v_cvt_pk_bf16_f32 v177, v152, v153
    v_mfma_f32_16x16x32_bf16 v[162:165], v[10:13], v[138:141], v[162:165]
    ds_read_b128 v[134:137], v246 offset:0
    v_exp_f32 v190, v190
    v_mfma_f32_16x16x32_bf16 v[218:221], v[108:111], v[180:183], 0
    ds_read_b128 v[138:141], v247 offset:0
    v_exp_f32 v191, v191
    v_mfma_f32_16x16x32_bf16 v[178:181], v[74:77], v[170:173], v[242:245]
    s_waitcnt lgkmcnt(5)
    buffer_store_dwordx4 v[154:157], v249, s[12:15], s42 offen sc1
    v_mfma_f32_16x16x32_bf16 v[182:185], v[78:81], v[170:173], v[242:245]
    v_cvt_pk_bf16_f32 v174, v162, v163
    v_cvt_pk_bf16_f32 v175, v164, v165
    v_mfma_f32_16x16x32_bf16 v[154:157], v[90:93], v[166:169], v[242:245]
    v_exp_f32 v192, v192
    v_mfma_f32_16x16x32_bf16 v[218:221], v[112:115], v[196:199], v[218:221]
    v_exp_f32 v193, v193
    v_mfma_f32_16x16x32_bf16 v[194:197], v[82:85], v[170:173], v[242:245]
    s_waitcnt lgkmcnt(3)
    v_cvt_pk_bf16_f32 v190, v190, v191
    v_cvt_pk_bf16_f32 v191, v192, v193
    v_mfma_f32_16x16x32_bf16 v[162:165], v[2:5], v[142:145], 0
    s_waitcnt lgkmcnt(2)
    buffer_store_dwordx4 v[158:161], v249, s[12:15], s43 offen sc1
    v_mfma_f32_16x16x32_bf16 v[150:153], v[6:9], v[142:145], 0
    v_exp_f32 v180, v180
    v_mfma_f32_16x16x32_bf16 v[162:165], v[10:13], v[146:149], v[162:165]
    ds_read_b128 v[142:145], v246 offset:2048
    v_exp_f32 v181, v181
    v_mfma_f32_16x16x32_bf16 v[150:153], v[14:17], v[146:149], v[150:153]
    v_exp_f32 v182, v182
    v_mfma_f32_16x16x32_bf16 v[198:201], v[86:89], v[170:173], v[242:245]
    ds_read_b128 v[146:149], v247 offset:2048
    v_exp_f32 v183, v183
    v_mfma_f32_16x16x32_bf16 v[234:237], v[238:241], v[188:191], v[234:237]
    s_waitcnt lgkmcnt(2)
    v_exp_f32 v157, v157
    v_mfma_f32_16x16x32_bf16 v[214:217], v[102:105], v[188:191], v[214:217]
    v_exp_f32 v178, v178
    v_mfma_f32_16x16x32_bf16 v[218:221], v[116:119], v[188:191], v[218:221]
    v_exp_f32 v179, v179
    v_mfma_f32_16x16x32_bf16 v[222:225], v[50:53], v[134:137], 0
    v_exp_f32 v184, v184
    v_mfma_f32_16x16x32_bf16 v[158:161], v[90:93], v[170:173], v[242:245]
    v_exp_f32 v185, v185
    v_mfma_f32_16x16x32_bf16 v[226:229], v[54:57], v[134:137], 0
    v_cvt_pk_bf16_f32 v181, v180, v181
    v_cvt_pk_bf16_f32 v182, v182, v183
    v_mfma_f32_16x16x32_bf16 v[222:225], v[58:61], v[138:141], v[222:225]
    ds_read_b128 v[134:137], v246 offset:4096
    v_cvt_pk_bf16_f32 v203, 0, v157
    v_cvt_pk_bf16_f32 v180, v178, v179
    v_mfma_f32_16x16x32_bf16 v[226:229], v[62:65], v[138:141], v[226:229]
    v_cvt_pk_bf16_f32 v183, v184, v185
    v_exp_f32 v196, v196
    v_mfma_f32_16x16x16_bf16 v[234:237], v[238:239], v[202:203], v[234:237]
    v_exp_f32 v197, v197
    v_exp_f32 v198, v198
    v_mfma_f32_16x16x32_bf16 v[230:233], v[238:241], v[180:183], v[230:233]
    s_waitcnt lgkmcnt(1)
    v_exp_f32 v199, v199
    v_mfma_f32_16x16x16_bf16 v[214:217], v[106:107], v[202:203], v[214:217]
    v_exp_f32 v194, v194
    v_cvt_pk_bf16_f32 v197, v196, v197
    v_mfma_f32_16x16x32_bf16 v[186:189], v[74:77], v[174:177], v[242:245]
    ds_read_b128 v[138:141], v247 offset:4096
    v_exp_f32 v195, v195
    v_mfma_f32_16x16x32_bf16 v[206:209], v[98:101], v[180:183], v[206:209]
    v_exp_f32 v200, v200
    v_mfma_f32_16x16x16_bf16 v[218:221], v[120:121], v[202:203], v[218:221]
    v_exp_f32 v201, v201
    v_cvt_pk_bf16_f32 v198, v198, v199
    v_mfma_f32_16x16x32_bf16 v[210:213], v[112:115], v[180:183], v[210:213]
    v_cvt_pk_bf16_f32 v196, v194, v195
    v_cvt_pk_bf16_f32 v199, v200, v201
    v_mfma_f32_16x16x32_bf16 v[178:181], v[66:69], v[174:177], v[242:245]
    v_rcp_f32 v235, v234
    v_mfma_f32_16x16x32_bf16 v[230:233], v[238:241], v[196:199], v[230:233]
    v_exp_f32 v161, v161
    v_mfma_f32_16x16x32_bf16 v[206:209], v[102:105], v[196:199], v[206:209]
    v_fma_f32 v214, v214, v235, v222
    v_fma_f32 v215, v215, v235, v223
    v_mfma_f32_16x16x32_bf16 v[210:213], v[116:119], v[196:199], v[210:213]
    v_fma_f32 v216, v216, v235, v224
    v_fma_f32 v217, v217, v235, v225
    v_mfma_f32_16x16x32_bf16 v[222:225], v[50:53], v[142:145], 0
    v_cvt_pk_bf16_f32 v205, 0, v161
    v_fma_f32 v218, v218, v235, v226
    v_mfma_f32_16x16x32_bf16 v[222:225], v[58:61], v[146:149], v[222:225]
    v_fma_f32 v219, v219, v235, v227
    v_fma_f32 v220, v220, v235, v228
    v_mfma_f32_16x16x16_bf16 v[230:233], v[238:239], v[204:205], v[230:233]
    v_fma_f32 v221, v221, v235, v229
    v_cvt_pk_bf16_f32 v214, v214, v215
    v_cvt_pk_bf16_f32 v215, v216, v217
    v_mfma_f32_16x16x32_bf16 v[226:229], v[54:57], v[142:145], 0
    s_waitcnt lgkmcnt(0)
    v_cvt_pk_bf16_f32 v216, v218, v219
    v_cvt_pk_bf16_f32 v217, v220, v221
    v_mfma_f32_16x16x16_bf16 v[206:209], v[106:107], v[204:205], v[206:209]
    v_rcp_f32 v231, v230
    v_pk_max_i16 v214, v214, 0
    v_mfma_f32_16x16x32_bf16 v[226:229], v[62:65], v[146:149], v[226:229]
    ds_read_b128 v[142:145], v246 offset:8192
    v_pk_max_i16 v215, v215, 0
    v_pk_max_i16 v216, v216, 0
    v_mfma_f32_16x16x16_bf16 v[210:213], v[120:121], v[204:205], v[210:213]
    v_pk_max_i16 v217, v217, 0
    v_fma_f32 v206, v206, v231, v222
    v_fma_f32 v207, v207, v231, v223
    v_mfma_f32_16x16x32_bf16 v[182:185], v[70:73], v[174:177], v[242:245]
    ds_write_b128 v252, v[214:217] offset:32768
    v_fma_f32 v208, v208, v231, v224
    v_fma_f32 v209, v209, v231, v225
    v_mfma_f32_16x16x32_bf16 v[190:193], v[78:81], v[174:177], v[242:245]
    ds_read_b128 v[146:149], v247 offset:8192
    v_cvt_pk_bf16_f32 v206, v206, v207
    v_fma_f32 v210, v210, v231, v226
    v_mfma_f32_16x16x32_bf16 v[222:225], v[50:53], v[134:137], 0
    v_fma_f32 v211, v211, v231, v227
    v_fma_f32 v212, v212, v231, v228
    v_mfma_f32_16x16x32_bf16 v[194:197], v[82:85], v[174:177], v[242:245]
    v_fma_f32 v213, v213, v231, v229
    v_cvt_pk_bf16_f32 v207, v208, v209
    v_mfma_f32_16x16x32_bf16 v[226:229], v[54:57], v[134:137], 0
    v_cvt_pk_bf16_f32 v208, v210, v211
    v_cvt_pk_bf16_f32 v209, v212, v213
    v_mfma_f32_16x16x32_bf16 v[198:201], v[86:89], v[174:177], v[242:245]
    ds_read_b128 v[134:137], v246 offset:6144
    v_pk_max_i16 v206, v206, 0
    v_pk_max_i16 v207, v207, 0
    v_mfma_f32_16x16x32_bf16 v[222:225], v[58:61], v[138:141], v[222:225]
    v_pk_max_i16 v208, v208, 0
    v_pk_max_i16 v209, v209, 0
    v_mfma_f32_16x16x32_bf16 v[226:229], v[62:65], v[138:141], v[226:229]
    ds_write_b128 v252, v[206:209] offset:34816
    v_cvt_pk_bf16_f32 v166, v162, v163
    v_cvt_pk_bf16_f32 v167, v164, v165
    ds_read_b128 v[138:141], v247 offset:6144
    v_cvt_pk_bf16_f32 v168, v150, v151
    v_cvt_pk_bf16_f32 v169, v152, v153
    v_exp_f32 v180, v180
    v_exp_f32 v181, v181
    v_exp_f32 v182, v182
    v_exp_f32 v183, v183
    v_exp_f32 v178, v178
    s_waitcnt lgkmcnt(3)
    v_mfma_f32_16x16x32_bf16 v[162:165], v[2:5], v[142:145], 0
    s_mov_b32 s39, 13107200
    v_exp_f32 v179, v179
    v_mfma_f32_16x16x32_bf16 v[150:153], v[6:9], v[142:145], 0
    s_lshl_b32 s40, s32, 6
    v_exp_f32 v184, v184
    v_mfma_f32_16x16x32_bf16 v[162:165], v[10:13], v[146:149], v[162:165]
    ds_read_b128 v[142:145], v246 offset:10240
    v_exp_f32 v185, v185
    v_mfma_f32_16x16x32_bf16 v[150:153], v[14:17], v[146:149], v[150:153]
    s_add_u32 s38, s33, s40
    v_cvt_pk_bf16_f32 v181, v180, v181
    v_cvt_pk_bf16_f32 v182, v182, v183
    ds_read_b128 v[146:149], v247 offset:10240
    v_cvt_pk_bf16_f32 v180, v178, v179
    v_cvt_pk_bf16_f32 v183, v184, v185
    v_exp_f32 v188, v188
    v_exp_f32 v189, v189
    v_mfma_f32_16x16x32_bf16 v[214:217], v[94:97], v[180:183], 0
    s_add_u32 s38, s38, 12288
    v_exp_f32 v190, v190
    v_mfma_f32_16x16x32_bf16 v[218:221], v[108:111], v[180:183], 0
    s_waitcnt lgkmcnt(2)
    v_exp_f32 v191, v191
    v_max3_u32 v0, v0, v230, v234
    v_min3_u32 v1, v1, v230, v234
    v_mfma_f32_16x16x32_bf16 v[234:237], v[238:241], v[180:183], 0
    s_barrier
    v_exp_f32 v186, v186
    v_mfma_f32_16x16x32_bf16 v[178:181], v[66:69], v[166:169], v[242:245]
    ds_read_b128 v[154:157], v253 offset:32768
    v_exp_f32 v187, v187
    v_mfma_f32_16x16x32_bf16 v[182:185], v[70:73], v[166:169], v[242:245]
    ds_read_b128 v[158:161], v253 offset:34816
    v_exp_f32 v192, v192
    v_exp_f32 v193, v193
    v_cvt_pk_bf16_f32 v189, v188, v189
    v_cvt_pk_bf16_f32 v190, v190, v191
    v_cvt_pk_bf16_f32 v188, v186, v187
    v_cvt_pk_bf16_f32 v191, v192, v193
    v_exp_f32 v196, v196
    v_exp_f32 v197, v197
    v_mfma_f32_16x16x32_bf16 v[234:237], v[238:241], v[188:191], v[234:237]
    s_waitcnt lgkmcnt(2)
    v_exp_f32 v198, v198
    v_mfma_f32_16x16x32_bf16 v[214:217], v[98:101], v[188:191], v[214:217]
    s_add_u32 s41, s33, 39325696
    v_exp_f32 v199, v199
    v_mfma_f32_16x16x32_bf16 v[218:221], v[112:115], v[188:191], v[218:221]
    s_add_u32 s42, s33, 39327744
    v_exp_f32 v194, v194
    v_mfma_f32_16x16x32_bf16 v[186:189], v[74:77], v[166:169], v[242:245]
    v_exp_f32 v195, v195
    v_mfma_f32_16x16x32_bf16 v[190:193], v[78:81], v[166:169], v[242:245]
    v_exp_f32 v200, v200
    v_exp_f32 v201, v201
    v_cvt_pk_bf16_f32 v197, v196, v197
    v_cvt_pk_bf16_f32 v198, v198, v199
    v_cvt_pk_bf16_f32 v170, v162, v163
    v_cvt_pk_bf16_f32 v171, v164, v165
    v_mfma_f32_16x16x32_bf16 v[162:165], v[122:125], v[70:73], v[242:245]
    s_waitcnt lgkmcnt(1)
    buffer_store_dwordx4 v[154:157], v249, s[12:15], s36 offen sc1
    v_cvt_pk_bf16_f32 v196, v194, v195
    v_cvt_pk_bf16_f32 v199, v200, v201
    v_mfma_f32_16x16x32_bf16 v[154:157], v[90:93], v[174:177], v[242:245]
    s_waitcnt lgkmcnt(0)
    buffer_store_dwordx4 v[158:161], v249, s[12:15], s37 offen sc1
    v_mfma_f32_16x16x32_bf16 v[234:237], v[238:241], v[196:199], v[234:237]
    v_cvt_pk_bf16_f32 v172, v150, v151
    v_cvt_pk_bf16_f32 v173, v152, v153
    v_mfma_f32_16x16x32_bf16 v[158:161], v[122:125], v[66:69], v[242:245]
    v_exp_f32 v195, v165
    v_mfma_f32_16x16x32_bf16 v[150:153], v[122:125], v[74:77], v[242:245]
    v_exp_f32 v157, v157
    v_mfma_f32_16x16x32_bf16 v[214:217], v[102:105], v[196:199], v[214:217]
    v_cvt_pk_bf16_f32 v203, 0, v157
    v_exp_f32 v180, v180
    v_mfma_f32_16x16x32_bf16 v[218:221], v[116:119], v[196:199], v[218:221]
    s_nop 0
    v_exp_f32 v194, v161
    v_mfma_f32_16x16x32_bf16 v[154:157], v[122:125], v[78:81], v[242:245]
    v_exp_f32 v196, v153
    v_mfma_f32_16x16x16_bf16 v[234:237], v[238:239], v[202:203], v[234:237]
    v_cvt_pk_bf16_f32 v194, v194, v195
    v_exp_f32 v181, v181
    v_mfma_f32_16x16x32_bf16 v[158:161], v[122:125], v[82:85], v[242:245]
    ds_write_b16 v250, v194 offset:0
    v_exp_f32 v182, v182
    v_mfma_f32_16x16x32_bf16 v[162:165], v[122:125], v[86:89], v[242:245]
    ds_write_b16_d16_hi v250, v194 offset:32
    v_exp_f32 v197, v157
    v_mfma_f32_16x16x32_bf16 v[150:153], v[122:125], v[90:93], v[242:245]
    v_rcp_f32 v235, v234
    v_mfma_f32_16x16x16_bf16 v[214:217], v[106:107], v[202:203], v[214:217]
    v_exp_f32 v198, v161
    v_cvt_pk_bf16_f32 v196, v196, v197
    v_mfma_f32_16x16x16_bf16 v[218:221], v[120:121], v[202:203], v[218:221]
    v_exp_f32 v199, v165
    v_cvt_pk_bf16_f32 v181, v180, v181
    v_mfma_f32_16x16x32_bf16 v[154:157], v[2:5], v[142:145], 0
    ds_write_b16 v250, v196 offset:64
    v_exp_f32 v200, v153
    v_mfma_f32_16x16x32_bf16 v[158:161], v[6:9], v[142:145], 0
    ds_write_b16_d16_hi v250, v196 offset:96
    v_fma_f32 v214, v214, v235, v222
    v_fma_f32 v215, v215, v235, v223
    v_mfma_f32_16x16x32_bf16 v[154:157], v[10:13], v[146:149], v[154:157]
    v_fma_f32 v216, v216, v235, v224
    v_fma_f32 v217, v217, v235, v225
    v_mfma_f32_16x16x32_bf16 v[222:225], v[50:53], v[134:137], 0
    v_fma_f32 v218, v218, v235, v226
    v_fma_f32 v219, v219, v235, v227
    v_mfma_f32_16x16x32_bf16 v[222:225], v[58:61], v[138:141], v[222:225]
    v_fma_f32 v220, v220, v235, v228
    v_fma_f32 v221, v221, v235, v229
    v_mfma_f32_16x16x32_bf16 v[226:229], v[54:57], v[134:137], 0
    v_cvt_pk_bf16_f32 v198, v198, v199
    v_cndmask_b32 v200, 0, v200, s[62:63]
    v_mfma_f32_16x16x32_bf16 v[226:229], v[62:65], v[138:141], v[226:229]
    ds_write_b16 v250, v198 offset:128
    v_cvt_pk_bf16_f32 v200, v200, 0
    v_exp_f32 v183, v183
    v_mfma_f32_16x16x32_bf16 v[158:161], v[14:17], v[146:149], v[158:161]
    ds_write_b16_d16_hi v250, v198 offset:160
    v_exp_f32 v178, v178
    v_mfma_f32_16x16x32_bf16 v[162:165], v[90:93], v[166:169], v[242:245]
    ds_write_b16 v250, v200 offset:192
    v_exp_f32 v179, v179
    v_mfma_f32_16x16x32_bf16 v[194:197], v[74:77], v[170:173], v[242:245]
    ds_read2_b64 v[134:137], v251 offset0:0 offset1:4
    v_exp_f32 v184, v184
    v_mfma_f32_16x16x32_bf16 v[198:201], v[78:81], v[170:173], v[242:245]
    ds_read2_b64 v[138:141], v251 offset0:8 offset1:12
    v_exp_f32 v185, v185
    ds_read2_b64 v[142:145], v251 offset0:16 offset1:20
    ds_read_b64 v[146:147], v251 offset:192
    v_cvt_pk_bf16_f32 v182, v182, v183
    v_cvt_pk_bf16_f32 v180, v178, v179
    v_cvt_pk_bf16_f32 v183, v184, v185
    v_max3_u32 v0, v0, v230, v234
    v_min3_u32 v1, v1, v230, v234
    v_mfma_f32_16x16x32_bf16 v[206:209], v[94:97], v[180:183], 0
    v_exp_f32 v188, v188
    v_mfma_f32_16x16x32_bf16 v[210:213], v[108:111], v[180:183], 0
    v_exp_f32 v189, v189
    v_mfma_f32_16x16x32_bf16 v[230:233], v[238:241], v[180:183], 0
    v_exp_f32 v190, v190
    v_mfma_f32_16x16x32_bf16 v[178:181], v[82:85], v[166:169], v[242:245]
    v_exp_f32 v191, v191
    v_mfma_f32_16x16x32_bf16 v[182:185], v[86:89], v[166:169], v[242:245]
    v_exp_f32 v186, v186
    v_exp_f32 v187, v187
    v_exp_f32 v192, v192
    v_exp_f32 v193, v193
    v_cvt_pk_bf16_f32 v189, v188, v189
    v_cvt_pk_bf16_f32 v190, v190, v191
    v_cvt_pk_bf16_f32 v188, v186, v187
    v_cvt_pk_bf16_f32 v191, v192, v193
    v_exp_f32 v180, v180
    v_exp_f32 v181, v181
    v_mfma_f32_16x16x32_bf16 v[230:233], v[238:241], v[188:191], v[230:233]
    s_waitcnt lgkmcnt(0)
    v_exp_f32 v182, v182
    v_mfma_f32_16x16x32_bf16 v[206:209], v[98:101], v[188:191], v[206:209]
    v_exp_f32 v183, v183
    v_mfma_f32_16x16x32_bf16 v[210:213], v[112:115], v[188:191], v[210:213]
    v_exp_f32 v178, v178
    v_mfma_f32_16x16x32_bf16 v[234:237], v[238:241], v[134:137], 0
    v_exp_f32 v179, v179
    v_mfma_f32_16x16x32_bf16 v[234:237], v[238:241], v[138:141], v[234:237]
    v_exp_f32 v184, v184
    v_mfma_f32_16x16x32_bf16 v[234:237], v[238:241], v[142:145], v[234:237]
    v_exp_f32 v185, v185
    v_mfma_f32_16x16x32_bf16 v[186:189], v[66:69], v[170:173], v[242:245]
    v_cvt_pk_bf16_f32 v181, v180, v181
    v_cvt_pk_bf16_f32 v182, v182, v183
    v_mfma_f32_16x16x32_bf16 v[190:193], v[70:73], v[170:173], v[242:245]
    v_cvt_pk_bf16_f32 v180, v178, v179
    v_cvt_pk_bf16_f32 v183, v184, v185
    v_mfma_f32_16x16x16_bf16 v[234:237], v[238:239], v[146:147], v[234:237]
    v_cvt_pk_bf16_f32 v214, v214, v215
    v_exp_f32 v165, v165
    v_mfma_f32_16x16x32_bf16 v[230:233], v[238:241], v[180:183], v[230:233]
    v_cvt_pk_bf16_f32 v215, v216, v217
    v_cvt_pk_bf16_f32 v216, v218, v219
    v_mfma_f32_16x16x32_bf16 v[206:209], v[102:105], v[180:183], v[206:209]
    v_cvt_pk_bf16_f32 v217, v220, v221
    v_cvt_pk_bf16_f32 v205, 0, v165
    v_mfma_f32_16x16x32_bf16 v[210:213], v[116:119], v[180:183], v[210:213]
    v_pk_max_i16 v214, v214, 0
    v_pk_max_i16 v215, v215, 0
    v_mfma_f32_16x16x16_bf16 v[230:233], v[238:239], v[204:205], v[230:233]
    v_pk_max_i16 v216, v216, 0
    v_pk_max_i16 v217, v217, 0
    v_exp_f32 v188, v188
    v_mfma_f32_16x16x32_bf16 v[218:221], v[108:111], v[134:137], 0
    ds_write_b128 v252, v[214:217] offset:0
    v_exp_f32 v189, v189
    v_mfma_f32_16x16x32_bf16 v[214:217], v[94:97], v[134:137], 0
    s_add_u32 s43, s33, 39329792
    v_rcp_f32 v231, v230
    v_mfma_f32_16x16x16_bf16 v[206:209], v[106:107], v[204:205], v[206:209]
    v_exp_f32 v190, v190
    v_cvt_pk_bf16_f32 v189, v188, v189
    v_mfma_f32_16x16x16_bf16 v[210:213], v[120:121], v[204:205], v[210:213]
    v_exp_f32 v191, v191
    v_max3_u32 v0, v0, v230, v234
    v_mfma_f32_16x16x32_bf16 v[214:217], v[98:101], v[138:141], v[214:217]
    ds_read_b128 v[134:137], v246 offset:8192
    v_exp_f32 v186, v186
    v_mfma_f32_16x16x32_bf16 v[218:221], v[112:115], v[138:141], v[218:221]
    s_lshl_b32 s37, s32, 6
    v_fma_f32 v206, v206, v231, v222
    v_fma_f32 v207, v207, v231, v223
    v_mfma_f32_16x16x32_bf16 v[178:181], v[82:85], v[170:173], v[242:245]
    ds_read_b128 v[138:141], v247 offset:8192
    v_fma_f32 v208, v208, v231, v224
    v_fma_f32 v209, v209, v231, v225
    v_mfma_f32_16x16x32_bf16 v[182:185], v[86:89], v[170:173], v[242:245]
    s_add_u32 s36, s33, s37
    v_cvt_pk_bf16_f32 v206, v206, v207
    v_fma_f32 v210, v210, v231, v226
    v_mfma_f32_16x16x32_bf16 v[162:165], v[90:93], v[170:173], v[242:245]
    s_add_u32 s36, s36, 39331840
    v_fma_f32 v211, v211, v231, v227
    v_fma_f32 v212, v212, v231, v228
    v_mfma_f32_16x16x32_bf16 v[214:217], v[102:105], v[142:145], v[214:217]
    v_fma_f32 v213, v213, v231, v229
    v_cvt_pk_bf16_f32 v207, v208, v209
    v_mfma_f32_16x16x32_bf16 v[218:221], v[116:119], v[142:145], v[218:221]
    v_cvt_pk_bf16_f32 v208, v210, v211
    v_cvt_pk_bf16_f32 v209, v212, v213
    ds_read_b128 v[142:145], v246 offset:10240
    v_mfma_f32_16x16x16_bf16 v[214:217], v[106:107], v[146:147], v[214:217]
    v_pk_max_i16 v206, v206, 0
    v_pk_max_i16 v207, v207, 0
    v_pk_max_i16 v208, v208, 0
    v_mfma_f32_16x16x16_bf16 v[218:221], v[120:121], v[146:147], v[218:221]
    v_pk_max_i16 v209, v209, 0
    v_exp_f32 v187, v187
    ds_read_b128 v[146:149], v247 offset:10240
    v_exp_f32 v192, v192
    v_exp_f32 v193, v193
    v_cvt_pk_bf16_f32 v190, v190, v191
    v_cvt_pk_bf16_f32 v188, v186, v187
    v_cvt_pk_bf16_f32 v191, v192, v193
    v_exp_f32 v196, v196
    v_exp_f32 v197, v197
    v_mfma_f32_16x16x32_bf16 v[210:213], v[108:111], v[188:191], 0
    ds_write_b128 v252, v[206:209] offset:2048
    v_exp_f32 v198, v198
    v_mfma_f32_16x16x32_bf16 v[206:209], v[94:97], v[188:191], 0
    s_waitcnt lgkmcnt(3)
    v_exp_f32 v199, v199
    v_mfma_f32_16x16x32_bf16 v[222:225], v[50:53], v[134:137], 0
    v_min3_u32 v1, v1, v230, v234
    v_cvt_pk_bf16_f32 v197, v196, v197
    v_mfma_f32_16x16x32_bf16 v[230:233], v[238:241], v[188:191], 0
    v_exp_f32 v194, v194
    v_mfma_f32_16x16x32_bf16 v[226:229], v[54:57], v[134:137], 0
    v_exp_f32 v195, v195
    v_mfma_f32_16x16x32_bf16 v[222:225], v[58:61], v[138:141], v[222:225]
    v_exp_f32 v200, v200
    v_mfma_f32_16x16x32_bf16 v[226:229], v[62:65], v[138:141], v[226:229]
    v_exp_f32 v201, v201
    s_waitcnt lgkmcnt(1)
    v_cvt_pk_bf16_f32 v198, v198, v199
    v_cvt_pk_bf16_f32 v196, v194, v195
    v_cvt_pk_bf16_f32 v199, v200, v201
    v_exp_f32 v180, v180
    v_exp_f32 v181, v181
    v_mfma_f32_16x16x32_bf16 v[230:233], v[238:241], v[196:199], v[230:233]
    v_exp_f32 v182, v182
    v_mfma_f32_16x16x32_bf16 v[206:209], v[98:101], v[196:199], v[206:209]
    v_exp_f32 v183, v183
    v_mfma_f32_16x16x32_bf16 v[210:213], v[112:115], v[196:199], v[210:213]
    v_exp_f32 v178, v178
    v_exp_f32 v179, v179
    v_exp_f32 v184, v184
    v_exp_f32 v185, v185
    v_cvt_pk_bf16_f32 v181, v180, v181
    v_cvt_pk_bf16_f32 v182, v182, v183
    v_cvt_pk_bf16_f32 v180, v178, v179
    v_cvt_pk_bf16_f32 v183, v184, v185
    v_exp_f32 v165, v165
    v_cvt_pk_bf16_f32 v174, v154, v155
    v_mfma_f32_16x16x32_bf16 v[230:233], v[238:241], v[180:183], v[230:233]
    s_waitcnt lgkmcnt(0)
    s_barrier
    v_cvt_pk_bf16_f32 v203, 0, v165
    v_cvt_pk_bf16_f32 v175, v156, v157
    v_mfma_f32_16x16x32_bf16 v[206:209], v[102:105], v[180:183], v[206:209]
    ds_read_b128 v[154:157], v253 offset:0
    v_cvt_pk_bf16_f32 v176, v158, v159
    v_cvt_pk_bf16_f32 v177, v160, v161
    v_mfma_f32_16x16x32_bf16 v[210:213], v[116:119], v[180:183], v[210:213]
    ds_read_b128 v[158:161], v253 offset:2048
    v_rcp_f32 v235, v234
    v_mfma_f32_16x16x32_bf16 v[186:189], v[66:69], v[174:177], v[242:245]
    v_mbcnt_lo_u32_b32 v150, -1, 0
    v_cndmask_b32 v235, 0, v235, s[62:63]
    v_mfma_f32_16x16x16_bf16 v[230:233], v[238:239], v[202:203], v[230:233]
    v_mbcnt_hi_u32_b32 v150, -1, v150
    v_fma_f32 v126, v214, v235, v126
    v_fma_f32 v127, v215, v235, v127
    v_mfma_f32_16x16x16_bf16 v[206:209], v[106:107], v[202:203], v[206:209]
    v_lshrrev_b32 v151, 4, v150
    v_bfe_u32 v152, v150, 2, 2
    v_fma_f32 v128, v216, v235, v128
    v_mfma_f32_16x16x16_bf16 v[210:213], v[120:121], v[202:203], v[210:213]
    v_rcp_f32 v231, v230
    v_fma_f32 v129, v217, v235, v129
    v_mfma_f32_16x16x32_bf16 v[190:193], v[70:73], v[174:177], v[242:245]
    s_nop 0
    v_fma_f32 v206, v206, v231, v222
    v_fma_f32 v207, v207, v231, v223
    v_mfma_f32_16x16x32_bf16 v[194:197], v[74:77], v[174:177], v[242:245]
    v_fma_f32 v208, v208, v231, v224
    v_fma_f32 v209, v209, v231, v225
    v_mfma_f32_16x16x32_bf16 v[198:201], v[78:81], v[174:177], v[242:245]
    v_cvt_pk_bf16_f32 v206, v206, v207
    v_fma_f32 v210, v210, v231, v226
    v_mfma_f32_16x16x32_bf16 v[178:181], v[82:85], v[174:177], v[242:245]
    v_fma_f32 v211, v211, v231, v227
    v_fma_f32 v212, v212, v231, v228
    v_mfma_f32_16x16x32_bf16 v[182:185], v[86:89], v[174:177], v[242:245]
    v_fma_f32 v213, v213, v231, v229
    v_cvt_pk_bf16_f32 v207, v208, v209
    v_mfma_f32_16x16x32_bf16 v[222:225], v[50:53], v[142:145], 0
    v_cvt_pk_bf16_f32 v208, v210, v211
    v_cvt_pk_bf16_f32 v209, v212, v213
    v_mfma_f32_16x16x32_bf16 v[226:229], v[54:57], v[142:145], 0
    v_pk_max_i16 v206, v206, 0
    v_pk_max_i16 v207, v207, 0
    v_mfma_f32_16x16x32_bf16 v[222:225], v[58:61], v[146:149], v[222:225]
    v_pk_max_i16 v208, v208, 0
    v_pk_max_i16 v209, v209, 0
    v_mfma_f32_16x16x32_bf16 v[226:229], v[62:65], v[146:149], v[226:229]
    ds_write_b128 v252, v[206:209] offset:4096
    v_cvt_pk_bf16_f32 v126, v126, v127
    v_and_b32 v150, 3, v150
    v_exp_f32 v188, v188
    v_exp_f32 v189, v189
    v_exp_f32 v190, v190
    v_exp_f32 v191, v191
    v_fma_f32 v130, v218, v235, v130
    v_fma_f32 v131, v219, v235, v131
    v_fma_f32 v132, v220, v235, v132
    v_fma_f32 v133, v221, v235, v133
    v_cvt_pk_bf16_f32 v127, v128, v129
    v_mul_lo_u32 v153, v150, s39
    v_exp_f32 v186, v186
    v_exp_f32 v187, v187
    v_exp_f32 v192, v192
    v_exp_f32 v193, v193
    v_cvt_pk_bf16_f32 v128, v130, v131
    v_cvt_pk_bf16_f32 v129, v132, v133
    v_lshl_add_u32 v153, v152, 7, v153
    v_cvt_pk_bf16_f32 v189, v188, v189
    v_cvt_pk_bf16_f32 v190, v190, v191
    v_pk_max_i16 v126, v126, 0
    v_pk_max_i16 v127, v127, 0
    v_pk_max_i16 v128, v128, 0
    v_pk_max_i16 v129, v129, 0
    v_lshl_add_u32 v153, v151, 4, v153
    v_cvt_pk_bf16_f32 v188, v186, v187
    v_cvt_pk_bf16_f32 v191, v192, v193
    v_exp_f32 v196, v196
    v_exp_f32 v197, v197
    v_mfma_f32_16x16x32_bf16 v[234:237], v[238:241], v[188:191], 0
    buffer_store_dwordx4 v[126:129], v153, s[12:15], s38 offen sc1
    v_mfma_f32_16x16x32_bf16 v[214:217], v[94:97], v[188:191], 0
    s_waitcnt lgkmcnt(2)
    buffer_store_dwordx4 v[154:157], v249, s[12:15], s41 offen sc1
    v_mfma_f32_16x16x32_bf16 v[218:221], v[108:111], v[188:191], 0
    s_waitcnt lgkmcnt(1)
    buffer_store_dwordx4 v[158:161], v249, s[12:15], s42 offen sc1
    v_mfma_f32_16x16x32_bf16 v[154:157], v[90:93], v[174:177], v[242:245]
    s_waitcnt lgkmcnt(0)
    s_barrier
    v_exp_f32 v198, v198
    ds_read_b128 v[150:153], v253 offset:4096
    v_exp_f32 v199, v199
    v_exp_f32 v194, v194
    v_exp_f32 v195, v195
    v_exp_f32 v200, v200
    v_exp_f32 v201, v201
    v_cvt_pk_bf16_f32 v197, v196, v197
    v_cvt_pk_bf16_f32 v198, v198, v199
    v_cvt_pk_bf16_f32 v196, v194, v195
    v_cvt_pk_bf16_f32 v199, v200, v201
    v_exp_f32 v180, v180
    v_exp_f32 v181, v181
    v_mfma_f32_16x16x32_bf16 v[234:237], v[238:241], v[196:199], v[234:237]
    v_exp_f32 v182, v182
    v_mfma_f32_16x16x32_bf16 v[214:217], v[98:101], v[196:199], v[214:217]
    v_exp_f32 v183, v183
    v_mfma_f32_16x16x32_bf16 v[218:221], v[112:115], v[196:199], v[218:221]
    v_exp_f32 v178, v178
    v_exp_f32 v179, v179
    v_exp_f32 v184, v184
    v_exp_f32 v185, v185
    v_cvt_pk_bf16_f32 v181, v180, v181
    v_cvt_pk_bf16_f32 v182, v182, v183
    v_cvt_pk_bf16_f32 v180, v178, v179
    v_cvt_pk_bf16_f32 v183, v184, v185
    v_exp_f32 v157, v157
    v_mbcnt_lo_u32_b32 v158, -1, 0
    v_mfma_f32_16x16x32_bf16 v[234:237], v[238:241], v[180:183], v[234:237]
    s_waitcnt lgkmcnt(0)
    buffer_store_dwordx4 v[150:153], v249, s[12:15], s43 offen sc1
    v_mfma_f32_16x16x32_bf16 v[214:217], v[102:105], v[180:183], v[214:217]
    v_cvt_pk_bf16_f32 v205, 0, v157
    v_mbcnt_hi_u32_b32 v158, -1, v158
    v_mfma_f32_16x16x32_bf16 v[218:221], v[116:119], v[180:183], v[218:221]
    v_and_b32 v159, 15, v158
    v_and_b32 v158, 48, v158
    v_mfma_f32_16x16x16_bf16 v[234:237], v[238:239], v[204:205], v[234:237]
    v_lshl_add_u32 v158, v159, 7, v158
    v_mfma_f32_16x16x16_bf16 v[214:217], v[106:107], v[204:205], v[214:217]
    s_nop 0
    v_mfma_f32_16x16x16_bf16 v[218:221], v[120:121], v[204:205], v[218:221]
    s_nop 3
    v_rcp_f32 v235, v234
    v_max3_u32 v0, v0, v230, v234
    v_fma_f32 v214, v214, v235, v222
    v_fma_f32 v215, v215, v235, v223
    v_fma_f32 v216, v216, v235, v224
    v_fma_f32 v217, v217, v235, v225
    v_cvt_pk_bf16_f32 v214, v214, v215
    v_fma_f32 v218, v218, v235, v226
    v_fma_f32 v219, v219, v235, v227
    v_fma_f32 v220, v220, v235, v228
    v_fma_f32 v221, v221, v235, v229
    v_cvt_pk_bf16_f32 v215, v216, v217
    v_cvt_pk_bf16_f32 v216, v218, v219
    v_cvt_pk_bf16_f32 v217, v220, v221
    v_pk_max_i16 v214, v214, 0
    v_pk_max_i16 v215, v215, 0
    v_pk_max_i16 v216, v216, 0
    v_pk_max_i16 v217, v217, 0
    v_min3_u32 v1, v1, v230, v234
    buffer_store_dwordx4 v[214:217], v158, s[12:15], s36 offen sc1
    v_cmp_lt_u32 vcc, s49, v0
    v_cmp_gt_u32 s[28:29], s48, v1
    s_waitcnt vmcnt(0)
    s_barrier
    s_or_b64 vcc, vcc, s[28:29]
    s_cbranch_scc1 L_safe
L_end:
L_done:
    s_endpgm
L_safe:
    s_waitcnt vmcnt(0)
    v_mbcnt_lo_u32_b32 v150, -1, 0
    v_mbcnt_hi_u32_b32 v150, -1, v150
    v_lshrrev_b32 v151, 4, v150
    v_and_b32 v152, 15, v150
    v_lshlrev_b32 v250, 7, v152
    v_lshl_add_u32 v250, v151, 4, v250
    v_and_b32 v150, 3, v152
    v_lshrrev_b32 v152, 2, v152
    v_lshlrev_b32 v152, 7, v152
    v_lshl_add_u32 v152, v151, 4, v152
    s_lshl_b32 s45, s32, 6
    v_cmp_ne_u32 vcc, 0, v150
    v_mov_b32 v153, 0x7f000000
    v_add_u32 v249, s45, v250
    v_cndmask_b32 v251, v152, v153, vcc
    v_add_u32 v248, s45, v251
    v_mov_b32 v203, 0
    s_mov_b32 s47, s33
    s_mov_b32 s35, 0
L_safe_loop:
    s_add_u32 s45, s47, 0
    buffer_load_dwordx4 v[134:137], v250, s[8:11], s45 offen
    buffer_load_dwordx4 v[138:141], v250, s[8:11], s45 offen offset:64
    s_waitcnt vmcnt(0)
    v_mfma_f32_16x16x32_bf16 v[150:153], v[18:21], v[134:137], 0
    v_mfma_f32_16x16x32_bf16 v[154:157], v[22:25], v[134:137], 0
    v_mfma_f32_16x16x32_bf16 v[150:153], v[26:29], v[138:141], v[150:153]
    v_mfma_f32_16x16x32_bf16 v[154:157], v[30:33], v[138:141], v[154:157]
    s_nop 6
    v_cvt_pk_bf16_f32 v66, v150, v151
    v_cvt_pk_bf16_f32 v67, v152, v153
    v_cvt_pk_bf16_f32 v68, v154, v155
    v_cvt_pk_bf16_f32 v69, v156, v157
    v_mfma_f32_16x16x32_bf16 v[158:161], v[134:137], v[34:37], 0
    v_mfma_f32_16x16x32_bf16 v[162:165], v[134:137], v[38:41], 0
    v_mfma_f32_16x16x32_bf16 v[158:161], v[138:141], v[42:45], v[158:161]
    v_mfma_f32_16x16x32_bf16 v[162:165], v[138:141], v[46:49], v[162:165]
    s_nop 6
    v_cvt_pk_bf16_f32 v94, v158, v159
    v_cvt_pk_bf16_f32 v95, v160, v161
    v_cvt_pk_bf16_f32 v108, v162, v163
    v_cvt_pk_bf16_f32 v109, v164, v165
    s_add_u32 s45, s47, 2048
    buffer_load_dwordx4 v[134:137], v250, s[8:11], s45 offen
    buffer_load_dwordx4 v[138:141], v250, s[8:11], s45 offen offset:64
    s_waitcnt vmcnt(0)
    v_mfma_f32_16x16x32_bf16 v[150:153], v[18:21], v[134:137], 0
    v_mfma_f32_16x16x32_bf16 v[154:157], v[22:25], v[134:137], 0
    v_mfma_f32_16x16x32_bf16 v[150:153], v[26:29], v[138:141], v[150:153]
    v_mfma_f32_16x16x32_bf16 v[154:157], v[30:33], v[138:141], v[154:157]
    s_nop 6
    v_cvt_pk_bf16_f32 v70, v150, v151
    v_cvt_pk_bf16_f32 v71, v152, v153
    v_cvt_pk_bf16_f32 v72, v154, v155
    v_cvt_pk_bf16_f32 v73, v156, v157
    v_mfma_f32_16x16x32_bf16 v[158:161], v[134:137], v[34:37], 0
    v_mfma_f32_16x16x32_bf16 v[162:165], v[134:137], v[38:41], 0
    v_mfma_f32_16x16x32_bf16 v[158:161], v[138:141], v[42:45], v[158:161]
    v_mfma_f32_16x16x32_bf16 v[162:165], v[138:141], v[46:49], v[162:165]
    s_nop 6
    v_cvt_pk_bf16_f32 v96, v158, v159
    v_cvt_pk_bf16_f32 v97, v160, v161
    v_cvt_pk_bf16_f32 v110, v162, v163
    v_cvt_pk_bf16_f32 v111, v164, v165
    s_add_u32 s45, s47, 4096
    buffer_load_dwordx4 v[134:137], v250, s[8:11], s45 offen
    buffer_load_dwordx4 v[138:141], v250, s[8:11], s45 offen offset:64
    s_waitcnt vmcnt(0)
    v_mfma_f32_16x16x32_bf16 v[150:153], v[18:21], v[134:137], 0
    v_mfma_f32_16x16x32_bf16 v[154:157], v[22:25], v[134:137], 0
    v_mfma_f32_16x16x32_bf16 v[150:153], v[26:29], v[138:141], v[150:153]
    v_mfma_f32_16x16x32_bf16 v[154:157], v[30:33], v[138:141], v[154:157]
    s_nop 6
    v_cvt_pk_bf16_f32 v74, v150, v151
    v_cvt_pk_bf16_f32 v75, v152, v153
    v_cvt_pk_bf16_f32 v76, v154, v155
    v_cvt_pk_bf16_f32 v77, v156, v157
    v_mfma_f32_16x16x32_bf16 v[158:161], v[134:137], v[34:37], 0
    v_mfma_f32_16x16x32_bf16 v[162:165], v[134:137], v[38:41], 0
    v_mfma_f32_16x16x32_bf16 v[158:161], v[138:141], v[42:45], v[158:161]
    v_mfma_f32_16x16x32_bf16 v[162:165], v[138:141], v[46:49], v[162:165]
    s_nop 6
    v_cvt_pk_bf16_f32 v98, v158, v159
    v_cvt_pk_bf16_f32 v99, v160, v161
    v_cvt_pk_bf16_f32 v112, v162, v163
    v_cvt_pk_bf16_f32 v113, v164, v165
    s_add_u32 s45, s47, 6144
    buffer_load_dwordx4 v[134:137], v250, s[8:11], s45 offen
    buffer_load_dwordx4 v[138:141], v250, s[8:11], s45 offen offset:64
    s_waitcnt vmcnt(0)
    v_mfma_f32_16x16x32_bf16 v[150:153], v[18:21], v[134:137], 0
    v_mfma_f32_16x16x32_bf16 v[154:157], v[22:25], v[134:137], 0
    v_mfma_f32_16x16x32_bf16 v[150:153], v[26:29], v[138:141], v[150:153]
    v_mfma_f32_16x16x32_bf16 v[154:157], v[30:33], v[138:141], v[154:157]
    s_nop 6
    v_cvt_pk_bf16_f32 v78, v150, v151
    v_cvt_pk_bf16_f32 v79, v152, v153
    v_cvt_pk_bf16_f32 v80, v154, v155
    v_cvt_pk_bf16_f32 v81, v156, v157
    v_mfma_f32_16x16x32_bf16 v[158:161], v[134:137], v[34:37], 0
    v_mfma_f32_16x16x32_bf16 v[162:165], v[134:137], v[38:41], 0
    v_mfma_f32_16x16x32_bf16 v[158:161], v[138:141], v[42:45], v[158:161]
    v_mfma_f32_16x16x32_bf16 v[162:165], v[138:141], v[46:49], v[162:165]
    s_nop 6
    v_cvt_pk_bf16_f32 v100, v158, v159
    v_cvt_pk_bf16_f32 v101, v160, v161
    v_cvt_pk_bf16_f32 v114, v162, v163
    v_cvt_pk_bf16_f32 v115, v164, v165
    s_add_u32 s45, s47, 8192
    buffer_load_dwordx4 v[134:137], v250, s[8:11], s45 offen
    buffer_load_dwordx4 v[138:141], v250, s[8:11], s45 offen offset:64
    s_waitcnt vmcnt(0)
    v_mfma_f32_16x16x32_bf16 v[150:153], v[18:21], v[134:137], 0
    v_mfma_f32_16x16x32_bf16 v[154:157], v[22:25], v[134:137], 0
    v_mfma_f32_16x16x32_bf16 v[150:153], v[26:29], v[138:141], v[150:153]
    v_mfma_f32_16x16x32_bf16 v[154:157], v[30:33], v[138:141], v[154:157]
    s_nop 6
    v_cvt_pk_bf16_f32 v82, v150, v151
    v_cvt_pk_bf16_f32 v83, v152, v153
    v_cvt_pk_bf16_f32 v84, v154, v155
    v_cvt_pk_bf16_f32 v85, v156, v157
    v_mfma_f32_16x16x32_bf16 v[158:161], v[134:137], v[34:37], 0
    v_mfma_f32_16x16x32_bf16 v[162:165], v[134:137], v[38:41], 0
    v_mfma_f32_16x16x32_bf16 v[158:161], v[138:141], v[42:45], v[158:161]
    v_mfma_f32_16x16x32_bf16 v[162:165], v[138:141], v[46:49], v[162:165]
    s_nop 6
    v_cvt_pk_bf16_f32 v102, v158, v159
    v_cvt_pk_bf16_f32 v103, v160, v161
    v_cvt_pk_bf16_f32 v116, v162, v163
    v_cvt_pk_bf16_f32 v117, v164, v165
    s_add_u32 s45, s47, 10240
    buffer_load_dwordx4 v[134:137], v250, s[8:11], s45 offen
    buffer_load_dwordx4 v[138:141], v250, s[8:11], s45 offen offset:64
    s_waitcnt vmcnt(0)
    v_mfma_f32_16x16x32_bf16 v[150:153], v[18:21], v[134:137], 0
    v_mfma_f32_16x16x32_bf16 v[154:157], v[22:25], v[134:137], 0
    v_mfma_f32_16x16x32_bf16 v[150:153], v[26:29], v[138:141], v[150:153]
    v_mfma_f32_16x16x32_bf16 v[154:157], v[30:33], v[138:141], v[154:157]
    s_nop 6
    v_cvt_pk_bf16_f32 v86, v150, v151
    v_cvt_pk_bf16_f32 v87, v152, v153
    v_cvt_pk_bf16_f32 v88, v154, v155
    v_cvt_pk_bf16_f32 v89, v156, v157
    v_mfma_f32_16x16x32_bf16 v[158:161], v[134:137], v[34:37], 0
    v_mfma_f32_16x16x32_bf16 v[162:165], v[134:137], v[38:41], 0
    v_mfma_f32_16x16x32_bf16 v[158:161], v[138:141], v[42:45], v[158:161]
    v_mfma_f32_16x16x32_bf16 v[162:165], v[138:141], v[46:49], v[162:165]
    s_nop 6
    v_cvt_pk_bf16_f32 v104, v158, v159
    v_cvt_pk_bf16_f32 v105, v160, v161
    v_cvt_pk_bf16_f32 v118, v162, v163
    v_cvt_pk_bf16_f32 v119, v164, v165
    s_add_u32 s45, s47, 12288
    buffer_load_dwordx4 v[134:137], v251, s[8:11], s45 offen
    buffer_load_dwordx4 v[138:141], v251, s[8:11], s45 offen offset:64
    s_waitcnt vmcnt(0)
    v_mfma_f32_16x16x32_bf16 v[150:153], v[18:21], v[134:137], 0
    v_mfma_f32_16x16x32_bf16 v[154:157], v[22:25], v[134:137], 0
    v_mfma_f32_16x16x32_bf16 v[150:153], v[26:29], v[138:141], v[150:153]
    v_mfma_f32_16x16x32_bf16 v[154:157], v[30:33], v[138:141], v[154:157]
    s_nop 6
    v_cvt_pk_bf16_f32 v90, v150, v151
    v_cvt_pk_bf16_f32 v91, v152, v153
    v_cvt_pk_bf16_f32 v92, v154, v155
    v_cvt_pk_bf16_f32 v93, v156, v157
    v_mfma_f32_16x16x32_bf16 v[158:161], v[134:137], v[34:37], 0
    v_mfma_f32_16x16x32_bf16 v[162:165], v[134:137], v[38:41], 0
    v_mfma_f32_16x16x32_bf16 v[158:161], v[138:141], v[42:45], v[158:161]
    v_mfma_f32_16x16x32_bf16 v[162:165], v[138:141], v[46:49], v[162:165]
    s_nop 6
    v_cvt_pk_bf16_f32 v106, v158, v159
    v_cvt_pk_bf16_f32 v107, v160, v161
    v_cvt_pk_bf16_f32 v120, v162, v163
    v_cvt_pk_bf16_f32 v121, v164, v165
    s_add_u32 s45, s47, 0
    buffer_load_dwordx4 v[134:137], v250, s[8:11], s45 offen
    buffer_load_dwordx4 v[138:141], v250, s[8:11], s45 offen offset:64
    s_waitcnt vmcnt(0)
    v_mfma_f32_16x16x32_bf16 v[150:153], v[2:5], v[134:137], 0
    v_mfma_f32_16x16x32_bf16 v[154:157], v[6:9], v[134:137], 0
    v_mfma_f32_16x16x32_bf16 v[150:153], v[10:13], v[138:141], v[150:153]
    v_mfma_f32_16x16x32_bf16 v[154:157], v[14:17], v[138:141], v[154:157]
    s_nop 6
    v_cvt_pk_bf16_f32 v166, v150, v151
    v_cvt_pk_bf16_f32 v167, v152, v153
    v_cvt_pk_bf16_f32 v168, v154, v155
    v_cvt_pk_bf16_f32 v169, v156, v157
    v_mfma_f32_16x16x32_bf16 v[126:129], v[50:53], v[134:137], 0
    v_mfma_f32_16x16x32_bf16 v[130:133], v[54:57], v[134:137], 0
    v_mfma_f32_16x16x32_bf16 v[126:129], v[58:61], v[138:141], v[126:129]
    v_mfma_f32_16x16x32_bf16 v[130:133], v[62:65], v[138:141], v[130:133]
    v_mfma_f32_16x16x32_bf16 v[178:181], v[66:69], v[166:169], 0
    v_mfma_f32_16x16x32_bf16 v[182:185], v[70:73], v[166:169], 0
    v_mfma_f32_16x16x32_bf16 v[186:189], v[74:77], v[166:169], 0
    v_mfma_f32_16x16x32_bf16 v[190:193], v[78:81], v[166:169], 0
    v_mfma_f32_16x16x32_bf16 v[194:197], v[82:85], v[166:169], 0
    v_mfma_f32_16x16x32_bf16 v[198:201], v[86:89], v[166:169], 0
    v_mfma_f32_16x16x32_bf16 v[214:217], v[90:93], v[166:169], 0
    s_nop 7
    v_mov_b32 v234, v214
    v_max3_f32 v234, v234, v178, v179
    v_max3_f32 v234, v234, v180, v181
    v_max3_f32 v234, v234, v182, v183
    v_max3_f32 v234, v234, v184, v185
    v_max3_f32 v234, v234, v186, v187
    v_max3_f32 v234, v234, v188, v189
    v_max3_f32 v234, v234, v190, v191
    v_max3_f32 v234, v234, v192, v193
    v_max3_f32 v234, v234, v194, v195
    v_max3_f32 v234, v234, v196, v197
    v_max3_f32 v234, v234, v198, v199
    v_max3_f32 v234, v234, v200, v201
    v_mov_b32 v235, v234
    s_nop 1
    v_permlane16_swap_b32 v234, v235
    v_max_f32 v234, v234, v235
    v_mov_b32 v235, v234
    s_nop 1
    v_permlane32_swap_b32 v234, v235
    v_max_f32 v234, v234, v235
    v_sub_f32 v178, v178, v234
    v_exp_f32 v178, v178
    v_sub_f32 v179, v179, v234
    v_exp_f32 v179, v179
    v_sub_f32 v180, v180, v234
    v_exp_f32 v180, v180
    v_sub_f32 v181, v181, v234
    v_exp_f32 v181, v181
    v_sub_f32 v182, v182, v234
    v_exp_f32 v182, v182
    v_sub_f32 v183, v183, v234
    v_exp_f32 v183, v183
    v_sub_f32 v184, v184, v234
    v_exp_f32 v184, v184
    v_sub_f32 v185, v185, v234
    v_exp_f32 v185, v185
    v_sub_f32 v186, v186, v234
    v_exp_f32 v186, v186
    v_sub_f32 v187, v187, v234
    v_exp_f32 v187, v187
    v_sub_f32 v188, v188, v234
    v_exp_f32 v188, v188
    v_sub_f32 v189, v189, v234
    v_exp_f32 v189, v189
    v_sub_f32 v190, v190, v234
    v_exp_f32 v190, v190
    v_sub_f32 v191, v191, v234
    v_exp_f32 v191, v191
    v_sub_f32 v192, v192, v234
    v_exp_f32 v192, v192
    v_sub_f32 v193, v193, v234
    v_exp_f32 v193, v193
    v_sub_f32 v194, v194, v234
    v_exp_f32 v194, v194
    v_sub_f32 v195, v195, v234
    v_exp_f32 v195, v195
    v_sub_f32 v196, v196, v234
    v_exp_f32 v196, v196
    v_sub_f32 v197, v197, v234
    v_exp_f32 v197, v197
    v_sub_f32 v198, v198, v234
    v_exp_f32 v198, v198
    v_sub_f32 v199, v199, v234
    v_exp_f32 v199, v199
    v_sub_f32 v200, v200, v234
    v_exp_f32 v200, v200
    v_sub_f32 v201, v201, v234
    v_exp_f32 v201, v201
    v_sub_f32 v214, v214, v234
    v_exp_f32 v214, v214
    v_cvt_pk_bf16_f32 v181, v180, v181
    v_cvt_pk_bf16_f32 v180, v178, v179
    v_cvt_pk_bf16_f32 v182, v182, v183
    v_cvt_pk_bf16_f32 v183, v184, v185
    s_nop 1
    v_mfma_f32_16x16x32_bf16 v[206:209], v[94:97], v[180:183], 0
    v_mfma_f32_16x16x32_bf16 v[210:213], v[108:111], v[180:183], 0
    v_mfma_f32_16x16x32_bf16 v[230:233], v[238:241], v[180:183], 0
    v_cvt_pk_bf16_f32 v189, v188, v189
    v_cvt_pk_bf16_f32 v188, v186, v187
    v_cvt_pk_bf16_f32 v190, v190, v191
    v_cvt_pk_bf16_f32 v191, v192, v193
    s_nop 1
    v_mfma_f32_16x16x32_bf16 v[206:209], v[98:101], v[188:191], v[206:209]
    v_mfma_f32_16x16x32_bf16 v[210:213], v[112:115], v[188:191], v[210:213]
    v_mfma_f32_16x16x32_bf16 v[230:233], v[238:241], v[188:191], v[230:233]
    v_cvt_pk_bf16_f32 v197, v196, v197
    v_cvt_pk_bf16_f32 v196, v194, v195
    v_cvt_pk_bf16_f32 v198, v198, v199
    v_cvt_pk_bf16_f32 v199, v200, v201
    s_nop 1
    v_mfma_f32_16x16x32_bf16 v[206:209], v[102:105], v[196:199], v[206:209]
    v_mfma_f32_16x16x32_bf16 v[210:213], v[116:119], v[196:199], v[210:213]
    v_mfma_f32_16x16x32_bf16 v[230:233], v[238:241], v[196:199], v[230:233]
    v_cvt_pk_bf16_f32 v202, v214, 0
    s_nop 2
    v_mfma_f32_16x16x16_bf16 v[206:209], v[106:107], v[202:203], v[206:209]
    v_mfma_f32_16x16x16_bf16 v[210:213], v[120:121], v[202:203], v[210:213]
    v_mfma_f32_16x16x16_bf16 v[230:233], v[238:239], v[202:203], v[230:233]
    s_nop 7
    v_rcp_f32 v231, v230
    s_nop 0
    v_fma_f32 v206, v206, v231, v126
    v_fma_f32 v207, v207, v231, v127
    v_fma_f32 v208, v208, v231, v128
    v_fma_f32 v209, v209, v231, v129
    v_fma_f32 v210, v210, v231, v130
    v_fma_f32 v211, v211, v231, v131
    v_fma_f32 v212, v212, v231, v132
    v_fma_f32 v213, v213, v231, v133
    v_cvt_pk_bf16_f32 v206, v206, v207
    v_cvt_pk_bf16_f32 v207, v208, v209
    v_cvt_pk_bf16_f32 v208, v210, v211
    v_cvt_pk_bf16_f32 v209, v212, v213
    v_pk_max_i16 v206, v206, 0
    v_pk_max_i16 v207, v207, 0
    v_pk_max_i16 v208, v208, 0
    v_pk_max_i16 v209, v209, 0
    s_add_u32 s46, s47, 0
    buffer_store_dwordx4 v[206:209], v249, s[12:15], s46 offen sc1
    s_add_u32 s45, s47, 2048
    buffer_load_dwordx4 v[134:137], v250, s[8:11], s45 offen
    buffer_load_dwordx4 v[138:141], v250, s[8:11], s45 offen offset:64
    s_waitcnt vmcnt(0)
    v_mfma_f32_16x16x32_bf16 v[158:161], v[2:5], v[134:137], 0
    v_mfma_f32_16x16x32_bf16 v[162:165], v[6:9], v[134:137], 0
    v_mfma_f32_16x16x32_bf16 v[158:161], v[10:13], v[138:141], v[158:161]
    v_mfma_f32_16x16x32_bf16 v[162:165], v[14:17], v[138:141], v[162:165]
    s_nop 6
    v_cvt_pk_bf16_f32 v166, v158, v159
    v_cvt_pk_bf16_f32 v167, v160, v161
    v_cvt_pk_bf16_f32 v168, v162, v163
    v_cvt_pk_bf16_f32 v169, v164, v165
    v_mfma_f32_16x16x32_bf16 v[126:129], v[50:53], v[134:137], 0
    v_mfma_f32_16x16x32_bf16 v[130:133], v[54:57], v[134:137], 0
    v_mfma_f32_16x16x32_bf16 v[126:129], v[58:61], v[138:141], v[126:129]
    v_mfma_f32_16x16x32_bf16 v[130:133], v[62:65], v[138:141], v[130:133]
    v_mfma_f32_16x16x32_bf16 v[178:181], v[66:69], v[166:169], 0
    v_mfma_f32_16x16x32_bf16 v[182:185], v[70:73], v[166:169], 0
    v_mfma_f32_16x16x32_bf16 v[186:189], v[74:77], v[166:169], 0
    v_mfma_f32_16x16x32_bf16 v[190:193], v[78:81], v[166:169], 0
    v_mfma_f32_16x16x32_bf16 v[194:197], v[82:85], v[166:169], 0
    v_mfma_f32_16x16x32_bf16 v[198:201], v[86:89], v[166:169], 0
    v_mfma_f32_16x16x32_bf16 v[214:217], v[90:93], v[166:169], 0
    s_nop 7
    v_mov_b32 v234, v214
    v_max3_f32 v234, v234, v178, v179
    v_max3_f32 v234, v234, v180, v181
    v_max3_f32 v234, v234, v182, v183
    v_max3_f32 v234, v234, v184, v185
    v_max3_f32 v234, v234, v186, v187
    v_max3_f32 v234, v234, v188, v189
    v_max3_f32 v234, v234, v190, v191
    v_max3_f32 v234, v234, v192, v193
    v_max3_f32 v234, v234, v194, v195
    v_max3_f32 v234, v234, v196, v197
    v_max3_f32 v234, v234, v198, v199
    v_max3_f32 v234, v234, v200, v201
    v_mov_b32 v235, v234
    s_nop 1
    v_permlane16_swap_b32 v234, v235
    v_max_f32 v234, v234, v235
    v_mov_b32 v235, v234
    s_nop 1
    v_permlane32_swap_b32 v234, v235
    v_max_f32 v234, v234, v235
    v_sub_f32 v178, v178, v234
    v_exp_f32 v178, v178
    v_sub_f32 v179, v179, v234
    v_exp_f32 v179, v179
    v_sub_f32 v180, v180, v234
    v_exp_f32 v180, v180
    v_sub_f32 v181, v181, v234
    v_exp_f32 v181, v181
    v_sub_f32 v182, v182, v234
    v_exp_f32 v182, v182
    v_sub_f32 v183, v183, v234
    v_exp_f32 v183, v183
    v_sub_f32 v184, v184, v234
    v_exp_f32 v184, v184
    v_sub_f32 v185, v185, v234
    v_exp_f32 v185, v185
    v_sub_f32 v186, v186, v234
    v_exp_f32 v186, v186
    v_sub_f32 v187, v187, v234
    v_exp_f32 v187, v187
    v_sub_f32 v188, v188, v234
    v_exp_f32 v188, v188
    v_sub_f32 v189, v189, v234
    v_exp_f32 v189, v189
    v_sub_f32 v190, v190, v234
    v_exp_f32 v190, v190
    v_sub_f32 v191, v191, v234
    v_exp_f32 v191, v191
    v_sub_f32 v192, v192, v234
    v_exp_f32 v192, v192
    v_sub_f32 v193, v193, v234
    v_exp_f32 v193, v193
    v_sub_f32 v194, v194, v234
    v_exp_f32 v194, v194
    v_sub_f32 v195, v195, v234
    v_exp_f32 v195, v195
    v_sub_f32 v196, v196, v234
    v_exp_f32 v196, v196
    v_sub_f32 v197, v197, v234
    v_exp_f32 v197, v197
    v_sub_f32 v198, v198, v234
    v_exp_f32 v198, v198
    v_sub_f32 v199, v199, v234
    v_exp_f32 v199, v199
    v_sub_f32 v200, v200, v234
    v_exp_f32 v200, v200
    v_sub_f32 v201, v201, v234
    v_exp_f32 v201, v201
    v_sub_f32 v214, v214, v234
    v_exp_f32 v214, v214
    v_cvt_pk_bf16_f32 v181, v180, v181
    v_cvt_pk_bf16_f32 v180, v178, v179
    v_cvt_pk_bf16_f32 v182, v182, v183
    v_cvt_pk_bf16_f32 v183, v184, v185
    s_nop 1
    v_mfma_f32_16x16x32_bf16 v[206:209], v[94:97], v[180:183], 0
    v_mfma_f32_16x16x32_bf16 v[210:213], v[108:111], v[180:183], 0
    v_mfma_f32_16x16x32_bf16 v[230:233], v[238:241], v[180:183], 0
    v_cvt_pk_bf16_f32 v189, v188, v189
    v_cvt_pk_bf16_f32 v188, v186, v187
    v_cvt_pk_bf16_f32 v190, v190, v191
    v_cvt_pk_bf16_f32 v191, v192, v193
    s_nop 1
    v_mfma_f32_16x16x32_bf16 v[206:209], v[98:101], v[188:191], v[206:209]
    v_mfma_f32_16x16x32_bf16 v[210:213], v[112:115], v[188:191], v[210:213]
    v_mfma_f32_16x16x32_bf16 v[230:233], v[238:241], v[188:191], v[230:233]
    v_cvt_pk_bf16_f32 v197, v196, v197
    v_cvt_pk_bf16_f32 v196, v194, v195
    v_cvt_pk_bf16_f32 v198, v198, v199
    v_cvt_pk_bf16_f32 v199, v200, v201
    s_nop 1
    v_mfma_f32_16x16x32_bf16 v[206:209], v[102:105], v[196:199], v[206:209]
    v_mfma_f32_16x16x32_bf16 v[210:213], v[116:119], v[196:199], v[210:213]
    v_mfma_f32_16x16x32_bf16 v[230:233], v[238:241], v[196:199], v[230:233]
    v_cvt_pk_bf16_f32 v202, v214, 0
    s_nop 2
    v_mfma_f32_16x16x16_bf16 v[206:209], v[106:107], v[202:203], v[206:209]
    v_mfma_f32_16x16x16_bf16 v[210:213], v[120:121], v[202:203], v[210:213]
    v_mfma_f32_16x16x16_bf16 v[230:233], v[238:239], v[202:203], v[230:233]
    s_nop 7
    v_rcp_f32 v231, v230
    s_nop 0
    v_fma_f32 v206, v206, v231, v126
    v_fma_f32 v207, v207, v231, v127
    v_fma_f32 v208, v208, v231, v128
    v_fma_f32 v209, v209, v231, v129
    v_fma_f32 v210, v210, v231, v130
    v_fma_f32 v211, v211, v231, v131
    v_fma_f32 v212, v212, v231, v132
    v_fma_f32 v213, v213, v231, v133
    v_cvt_pk_bf16_f32 v206, v206, v207
    v_cvt_pk_bf16_f32 v207, v208, v209
    v_cvt_pk_bf16_f32 v208, v210, v211
    v_cvt_pk_bf16_f32 v209, v212, v213
    v_pk_max_i16 v206, v206, 0
    v_pk_max_i16 v207, v207, 0
    v_pk_max_i16 v208, v208, 0
    v_pk_max_i16 v209, v209, 0
    s_add_u32 s46, s47, 2048
    buffer_store_dwordx4 v[206:209], v249, s[12:15], s46 offen sc1
    s_add_u32 s45, s47, 4096
    buffer_load_dwordx4 v[134:137], v250, s[8:11], s45 offen
    buffer_load_dwordx4 v[138:141], v250, s[8:11], s45 offen offset:64
    s_waitcnt vmcnt(0)
    v_mfma_f32_16x16x32_bf16 v[150:153], v[2:5], v[134:137], 0
    v_mfma_f32_16x16x32_bf16 v[154:157], v[6:9], v[134:137], 0
    v_mfma_f32_16x16x32_bf16 v[150:153], v[10:13], v[138:141], v[150:153]
    v_mfma_f32_16x16x32_bf16 v[154:157], v[14:17], v[138:141], v[154:157]
    s_nop 6
    v_cvt_pk_bf16_f32 v166, v150, v151
    v_cvt_pk_bf16_f32 v167, v152, v153
    v_cvt_pk_bf16_f32 v168, v154, v155
    v_cvt_pk_bf16_f32 v169, v156, v157
    v_mfma_f32_16x16x32_bf16 v[126:129], v[50:53], v[134:137], 0
    v_mfma_f32_16x16x32_bf16 v[130:133], v[54:57], v[134:137], 0
    v_mfma_f32_16x16x32_bf16 v[126:129], v[58:61], v[138:141], v[126:129]
    v_mfma_f32_16x16x32_bf16 v[130:133], v[62:65], v[138:141], v[130:133]
    v_mfma_f32_16x16x32_bf16 v[178:181], v[66:69], v[166:169], 0
    v_mfma_f32_16x16x32_bf16 v[182:185], v[70:73], v[166:169], 0
    v_mfma_f32_16x16x32_bf16 v[186:189], v[74:77], v[166:169], 0
    v_mfma_f32_16x16x32_bf16 v[190:193], v[78:81], v[166:169], 0
    v_mfma_f32_16x16x32_bf16 v[194:197], v[82:85], v[166:169], 0
    v_mfma_f32_16x16x32_bf16 v[198:201], v[86:89], v[166:169], 0
    v_mfma_f32_16x16x32_bf16 v[214:217], v[90:93], v[166:169], 0
    s_nop 7
    v_mov_b32 v234, v214
    v_max3_f32 v234, v234, v178, v179
    v_max3_f32 v234, v234, v180, v181
    v_max3_f32 v234, v234, v182, v183
    v_max3_f32 v234, v234, v184, v185
    v_max3_f32 v234, v234, v186, v187
    v_max3_f32 v234, v234, v188, v189
    v_max3_f32 v234, v234, v190, v191
    v_max3_f32 v234, v234, v192, v193
    v_max3_f32 v234, v234, v194, v195
    v_max3_f32 v234, v234, v196, v197
    v_max3_f32 v234, v234, v198, v199
    v_max3_f32 v234, v234, v200, v201
    v_mov_b32 v235, v234
    s_nop 1
    v_permlane16_swap_b32 v234, v235
    v_max_f32 v234, v234, v235
    v_mov_b32 v235, v234
    s_nop 1
    v_permlane32_swap_b32 v234, v235
    v_max_f32 v234, v234, v235
    v_sub_f32 v178, v178, v234
    v_exp_f32 v178, v178
    v_sub_f32 v179, v179, v234
    v_exp_f32 v179, v179
    v_sub_f32 v180, v180, v234
    v_exp_f32 v180, v180
    v_sub_f32 v181, v181, v234
    v_exp_f32 v181, v181
    v_sub_f32 v182, v182, v234
    v_exp_f32 v182, v182
    v_sub_f32 v183, v183, v234
    v_exp_f32 v183, v183
    v_sub_f32 v184, v184, v234
    v_exp_f32 v184, v184
    v_sub_f32 v185, v185, v234
    v_exp_f32 v185, v185
    v_sub_f32 v186, v186, v234
    v_exp_f32 v186, v186
    v_sub_f32 v187, v187, v234
    v_exp_f32 v187, v187
    v_sub_f32 v188, v188, v234
    v_exp_f32 v188, v188
    v_sub_f32 v189, v189, v234
    v_exp_f32 v189, v189
    v_sub_f32 v190, v190, v234
    v_exp_f32 v190, v190
    v_sub_f32 v191, v191, v234
    v_exp_f32 v191, v191
    v_sub_f32 v192, v192, v234
    v_exp_f32 v192, v192
    v_sub_f32 v193, v193, v234
    v_exp_f32 v193, v193
    v_sub_f32 v194, v194, v234
    v_exp_f32 v194, v194
    v_sub_f32 v195, v195, v234
    v_exp_f32 v195, v195
    v_sub_f32 v196, v196, v234
    v_exp_f32 v196, v196
    v_sub_f32 v197, v197, v234
    v_exp_f32 v197, v197
    v_sub_f32 v198, v198, v234
    v_exp_f32 v198, v198
    v_sub_f32 v199, v199, v234
    v_exp_f32 v199, v199
    v_sub_f32 v200, v200, v234
    v_exp_f32 v200, v200
    v_sub_f32 v201, v201, v234
    v_exp_f32 v201, v201
    v_sub_f32 v214, v214, v234
    v_exp_f32 v214, v214
    v_cvt_pk_bf16_f32 v181, v180, v181
    v_cvt_pk_bf16_f32 v180, v178, v179
    v_cvt_pk_bf16_f32 v182, v182, v183
    v_cvt_pk_bf16_f32 v183, v184, v185
    s_nop 1
    v_mfma_f32_16x16x32_bf16 v[206:209], v[94:97], v[180:183], 0
    v_mfma_f32_16x16x32_bf16 v[210:213], v[108:111], v[180:183], 0
    v_mfma_f32_16x16x32_bf16 v[230:233], v[238:241], v[180:183], 0
    v_cvt_pk_bf16_f32 v189, v188, v189
    v_cvt_pk_bf16_f32 v188, v186, v187
    v_cvt_pk_bf16_f32 v190, v190, v191
    v_cvt_pk_bf16_f32 v191, v192, v193
    s_nop 1
    v_mfma_f32_16x16x32_bf16 v[206:209], v[98:101], v[188:191], v[206:209]
    v_mfma_f32_16x16x32_bf16 v[210:213], v[112:115], v[188:191], v[210:213]
    v_mfma_f32_16x16x32_bf16 v[230:233], v[238:241], v[188:191], v[230:233]
    v_cvt_pk_bf16_f32 v197, v196, v197
    v_cvt_pk_bf16_f32 v196, v194, v195
    v_cvt_pk_bf16_f32 v198, v198, v199
    v_cvt_pk_bf16_f32 v199, v200, v201
    s_nop 1
    v_mfma_f32_16x16x32_bf16 v[206:209], v[102:105], v[196:199], v[206:209]
    v_mfma_f32_16x16x32_bf16 v[210:213], v[116:119], v[196:199], v[210:213]
    v_mfma_f32_16x16x32_bf16 v[230:233], v[238:241], v[196:199], v[230:233]
    v_cvt_pk_bf16_f32 v202, v214, 0
    s_nop 2
    v_mfma_f32_16x16x16_bf16 v[206:209], v[106:107], v[202:203], v[206:209]
    v_mfma_f32_16x16x16_bf16 v[210:213], v[120:121], v[202:203], v[210:213]
    v_mfma_f32_16x16x16_bf16 v[230:233], v[238:239], v[202:203], v[230:233]
    s_nop 7
    v_rcp_f32 v231, v230
    s_nop 0
    v_fma_f32 v206, v206, v231, v126
    v_fma_f32 v207, v207, v231, v127
    v_fma_f32 v208, v208, v231, v128
    v_fma_f32 v209, v209, v231, v129
    v_fma_f32 v210, v210, v231, v130
    v_fma_f32 v211, v211, v231, v131
    v_fma_f32 v212, v212, v231, v132
    v_fma_f32 v213, v213, v231, v133
    v_cvt_pk_bf16_f32 v206, v206, v207
    v_cvt_pk_bf16_f32 v207, v208, v209
    v_cvt_pk_bf16_f32 v208, v210, v211
    v_cvt_pk_bf16_f32 v209, v212, v213
    v_pk_max_i16 v206, v206, 0
    v_pk_max_i16 v207, v207, 0
    v_pk_max_i16 v208, v208, 0
    v_pk_max_i16 v209, v209, 0
    s_add_u32 s46, s47, 4096
    buffer_store_dwordx4 v[206:209], v249, s[12:15], s46 offen sc1
    s_add_u32 s45, s47, 6144
    buffer_load_dwordx4 v[134:137], v250, s[8:11], s45 offen
    buffer_load_dwordx4 v[138:141], v250, s[8:11], s45 offen offset:64
    s_waitcnt vmcnt(0)
    v_mfma_f32_16x16x32_bf16 v[158:161], v[2:5], v[134:137], 0
    v_mfma_f32_16x16x32_bf16 v[162:165], v[6:9], v[134:137], 0
    v_mfma_f32_16x16x32_bf16 v[158:161], v[10:13], v[138:141], v[158:161]
    v_mfma_f32_16x16x32_bf16 v[162:165], v[14:17], v[138:141], v[162:165]
    s_nop 6
    v_cvt_pk_bf16_f32 v166, v158, v159
    v_cvt_pk_bf16_f32 v167, v160, v161
    v_cvt_pk_bf16_f32 v168, v162, v163
    v_cvt_pk_bf16_f32 v169, v164, v165
    v_mfma_f32_16x16x32_bf16 v[126:129], v[50:53], v[134:137], 0
    v_mfma_f32_16x16x32_bf16 v[130:133], v[54:57], v[134:137], 0
    v_mfma_f32_16x16x32_bf16 v[126:129], v[58:61], v[138:141], v[126:129]
    v_mfma_f32_16x16x32_bf16 v[130:133], v[62:65], v[138:141], v[130:133]
    v_mfma_f32_16x16x32_bf16 v[178:181], v[66:69], v[166:169], 0
    v_mfma_f32_16x16x32_bf16 v[182:185], v[70:73], v[166:169], 0
    v_mfma_f32_16x16x32_bf16 v[186:189], v[74:77], v[166:169], 0
    v_mfma_f32_16x16x32_bf16 v[190:193], v[78:81], v[166:169], 0
    v_mfma_f32_16x16x32_bf16 v[194:197], v[82:85], v[166:169], 0
    v_mfma_f32_16x16x32_bf16 v[198:201], v[86:89], v[166:169], 0
    v_mfma_f32_16x16x32_bf16 v[214:217], v[90:93], v[166:169], 0
    s_nop 7
    v_mov_b32 v234, v214
    v_max3_f32 v234, v234, v178, v179
    v_max3_f32 v234, v234, v180, v181
    v_max3_f32 v234, v234, v182, v183
    v_max3_f32 v234, v234, v184, v185
    v_max3_f32 v234, v234, v186, v187
    v_max3_f32 v234, v234, v188, v189
    v_max3_f32 v234, v234, v190, v191
    v_max3_f32 v234, v234, v192, v193
    v_max3_f32 v234, v234, v194, v195
    v_max3_f32 v234, v234, v196, v197
    v_max3_f32 v234, v234, v198, v199
    v_max3_f32 v234, v234, v200, v201
    v_mov_b32 v235, v234
    s_nop 1
    v_permlane16_swap_b32 v234, v235
    v_max_f32 v234, v234, v235
    v_mov_b32 v235, v234
    s_nop 1
    v_permlane32_swap_b32 v234, v235
    v_max_f32 v234, v234, v235
    v_sub_f32 v178, v178, v234
    v_exp_f32 v178, v178
    v_sub_f32 v179, v179, v234
    v_exp_f32 v179, v179
    v_sub_f32 v180, v180, v234
    v_exp_f32 v180, v180
    v_sub_f32 v181, v181, v234
    v_exp_f32 v181, v181
    v_sub_f32 v182, v182, v234
    v_exp_f32 v182, v182
    v_sub_f32 v183, v183, v234
    v_exp_f32 v183, v183
    v_sub_f32 v184, v184, v234
    v_exp_f32 v184, v184
    v_sub_f32 v185, v185, v234
    v_exp_f32 v185, v185
    v_sub_f32 v186, v186, v234
    v_exp_f32 v186, v186
    v_sub_f32 v187, v187, v234
    v_exp_f32 v187, v187
    v_sub_f32 v188, v188, v234
    v_exp_f32 v188, v188
    v_sub_f32 v189, v189, v234
    v_exp_f32 v189, v189
    v_sub_f32 v190, v190, v234
    v_exp_f32 v190, v190
    v_sub_f32 v191, v191, v234
    v_exp_f32 v191, v191
    v_sub_f32 v192, v192, v234
    v_exp_f32 v192, v192
    v_sub_f32 v193, v193, v234
    v_exp_f32 v193, v193
    v_sub_f32 v194, v194, v234
    v_exp_f32 v194, v194
    v_sub_f32 v195, v195, v234
    v_exp_f32 v195, v195
    v_sub_f32 v196, v196, v234
    v_exp_f32 v196, v196
    v_sub_f32 v197, v197, v234
    v_exp_f32 v197, v197
    v_sub_f32 v198, v198, v234
    v_exp_f32 v198, v198
    v_sub_f32 v199, v199, v234
    v_exp_f32 v199, v199
    v_sub_f32 v200, v200, v234
    v_exp_f32 v200, v200
    v_sub_f32 v201, v201, v234
    v_exp_f32 v201, v201
    v_sub_f32 v214, v214, v234
    v_exp_f32 v214, v214
    v_cvt_pk_bf16_f32 v181, v180, v181
    v_cvt_pk_bf16_f32 v180, v178, v179
    v_cvt_pk_bf16_f32 v182, v182, v183
    v_cvt_pk_bf16_f32 v183, v184, v185
    s_nop 1
    v_mfma_f32_16x16x32_bf16 v[206:209], v[94:97], v[180:183], 0
    v_mfma_f32_16x16x32_bf16 v[210:213], v[108:111], v[180:183], 0
    v_mfma_f32_16x16x32_bf16 v[230:233], v[238:241], v[180:183], 0
    v_cvt_pk_bf16_f32 v189, v188, v189
    v_cvt_pk_bf16_f32 v188, v186, v187
    v_cvt_pk_bf16_f32 v190, v190, v191
    v_cvt_pk_bf16_f32 v191, v192, v193
    s_nop 1
    v_mfma_f32_16x16x32_bf16 v[206:209], v[98:101], v[188:191], v[206:209]
    v_mfma_f32_16x16x32_bf16 v[210:213], v[112:115], v[188:191], v[210:213]
    v_mfma_f32_16x16x32_bf16 v[230:233], v[238:241], v[188:191], v[230:233]
    v_cvt_pk_bf16_f32 v197, v196, v197
    v_cvt_pk_bf16_f32 v196, v194, v195
    v_cvt_pk_bf16_f32 v198, v198, v199
    v_cvt_pk_bf16_f32 v199, v200, v201
    s_nop 1
    v_mfma_f32_16x16x32_bf16 v[206:209], v[102:105], v[196:199], v[206:209]
    v_mfma_f32_16x16x32_bf16 v[210:213], v[116:119], v[196:199], v[210:213]
    v_mfma_f32_16x16x32_bf16 v[230:233], v[238:241], v[196:199], v[230:233]
    v_cvt_pk_bf16_f32 v202, v214, 0
    s_nop 2
    v_mfma_f32_16x16x16_bf16 v[206:209], v[106:107], v[202:203], v[206:209]
    v_mfma_f32_16x16x16_bf16 v[210:213], v[120:121], v[202:203], v[210:213]
    v_mfma_f32_16x16x16_bf16 v[230:233], v[238:239], v[202:203], v[230:233]
    s_nop 7
    v_rcp_f32 v231, v230
    s_nop 0
    v_fma_f32 v206, v206, v231, v126
    v_fma_f32 v207, v207, v231, v127
    v_fma_f32 v208, v208, v231, v128
    v_fma_f32 v209, v209, v231, v129
    v_fma_f32 v210, v210, v231, v130
    v_fma_f32 v211, v211, v231, v131
    v_fma_f32 v212, v212, v231, v132
    v_fma_f32 v213, v213, v231, v133
    v_cvt_pk_bf16_f32 v206, v206, v207
    v_cvt_pk_bf16_f32 v207, v208, v209
    v_cvt_pk_bf16_f32 v208, v210, v211
    v_cvt_pk_bf16_f32 v209, v212, v213
    v_pk_max_i16 v206, v206, 0
    v_pk_max_i16 v207, v207, 0
    v_pk_max_i16 v208, v208, 0
    v_pk_max_i16 v209, v209, 0
    s_add_u32 s46, s47, 6144
    buffer_store_dwordx4 v[206:209], v249, s[12:15], s46 offen sc1
    s_add_u32 s45, s47, 8192
    buffer_load_dwordx4 v[134:137], v250, s[8:11], s45 offen
    buffer_load_dwordx4 v[138:141], v250, s[8:11], s45 offen offset:64
    s_waitcnt vmcnt(0)
    v_mfma_f32_16x16x32_bf16 v[150:153], v[2:5], v[134:137], 0
    v_mfma_f32_16x16x32_bf16 v[154:157], v[6:9], v[134:137], 0
    v_mfma_f32_16x16x32_bf16 v[150:153], v[10:13], v[138:141], v[150:153]
    v_mfma_f32_16x16x32_bf16 v[154:157], v[14:17], v[138:141], v[154:157]
    s_nop 6
    v_cvt_pk_bf16_f32 v166, v150, v151
    v_cvt_pk_bf16_f32 v167, v152, v153
    v_cvt_pk_bf16_f32 v168, v154, v155
    v_cvt_pk_bf16_f32 v169, v156, v157
    v_mfma_f32_16x16x32_bf16 v[126:129], v[50:53], v[134:137], 0
    v_mfma_f32_16x16x32_bf16 v[130:133], v[54:57], v[134:137], 0
    v_mfma_f32_16x16x32_bf16 v[126:129], v[58:61], v[138:141], v[126:129]
    v_mfma_f32_16x16x32_bf16 v[130:133], v[62:65], v[138:141], v[130:133]
    v_mfma_f32_16x16x32_bf16 v[178:181], v[66:69], v[166:169], 0
    v_mfma_f32_16x16x32_bf16 v[182:185], v[70:73], v[166:169], 0
    v_mfma_f32_16x16x32_bf16 v[186:189], v[74:77], v[166:169], 0
    v_mfma_f32_16x16x32_bf16 v[190:193], v[78:81], v[166:169], 0
    v_mfma_f32_16x16x32_bf16 v[194:197], v[82:85], v[166:169], 0
    v_mfma_f32_16x16x32_bf16 v[198:201], v[86:89], v[166:169], 0
    v_mfma_f32_16x16x32_bf16 v[214:217], v[90:93], v[166:169], 0
    s_nop 7
    v_mov_b32 v234, v214
    v_max3_f32 v234, v234, v178, v179
    v_max3_f32 v234, v234, v180, v181
    v_max3_f32 v234, v234, v182, v183
    v_max3_f32 v234, v234, v184, v185
    v_max3_f32 v234, v234, v186, v187
    v_max3_f32 v234, v234, v188, v189
    v_max3_f32 v234, v234, v190, v191
    v_max3_f32 v234, v234, v192, v193
    v_max3_f32 v234, v234, v194, v195
    v_max3_f32 v234, v234, v196, v197
    v_max3_f32 v234, v234, v198, v199
    v_max3_f32 v234, v234, v200, v201
    v_mov_b32 v235, v234
    s_nop 1
    v_permlane16_swap_b32 v234, v235
    v_max_f32 v234, v234, v235
    v_mov_b32 v235, v234
    s_nop 1
    v_permlane32_swap_b32 v234, v235
    v_max_f32 v234, v234, v235
    v_sub_f32 v178, v178, v234
    v_exp_f32 v178, v178
    v_sub_f32 v179, v179, v234
    v_exp_f32 v179, v179
    v_sub_f32 v180, v180, v234
    v_exp_f32 v180, v180
    v_sub_f32 v181, v181, v234
    v_exp_f32 v181, v181
    v_sub_f32 v182, v182, v234
    v_exp_f32 v182, v182
    v_sub_f32 v183, v183, v234
    v_exp_f32 v183, v183
    v_sub_f32 v184, v184, v234
    v_exp_f32 v184, v184
    v_sub_f32 v185, v185, v234
    v_exp_f32 v185, v185
    v_sub_f32 v186, v186, v234
    v_exp_f32 v186, v186
    v_sub_f32 v187, v187, v234
    v_exp_f32 v187, v187
    v_sub_f32 v188, v188, v234
    v_exp_f32 v188, v188
    v_sub_f32 v189, v189, v234
    v_exp_f32 v189, v189
    v_sub_f32 v190, v190, v234
    v_exp_f32 v190, v190
    v_sub_f32 v191, v191, v234
    v_exp_f32 v191, v191
    v_sub_f32 v192, v192, v234
    v_exp_f32 v192, v192
    v_sub_f32 v193, v193, v234
    v_exp_f32 v193, v193
    v_sub_f32 v194, v194, v234
    v_exp_f32 v194, v194
    v_sub_f32 v195, v195, v234
    v_exp_f32 v195, v195
    v_sub_f32 v196, v196, v234
    v_exp_f32 v196, v196
    v_sub_f32 v197, v197, v234
    v_exp_f32 v197, v197
    v_sub_f32 v198, v198, v234
    v_exp_f32 v198, v198
    v_sub_f32 v199, v199, v234
    v_exp_f32 v199, v199
    v_sub_f32 v200, v200, v234
    v_exp_f32 v200, v200
    v_sub_f32 v201, v201, v234
    v_exp_f32 v201, v201
    v_sub_f32 v214, v214, v234
    v_exp_f32 v214, v214
    v_cvt_pk_bf16_f32 v181, v180, v181
    v_cvt_pk_bf16_f32 v180, v178, v179
    v_cvt_pk_bf16_f32 v182, v182, v183
    v_cvt_pk_bf16_f32 v183, v184, v185
    s_nop 1
    v_mfma_f32_16x16x32_bf16 v[206:209], v[94:97], v[180:183], 0
    v_mfma_f32_16x16x32_bf16 v[210:213], v[108:111], v[180:183], 0
    v_mfma_f32_16x16x32_bf16 v[230:233], v[238:241], v[180:183], 0
    v_cvt_pk_bf16_f32 v189, v188, v189
    v_cvt_pk_bf16_f32 v188, v186, v187
    v_cvt_pk_bf16_f32 v190, v190, v191
    v_cvt_pk_bf16_f32 v191, v192, v193
    s_nop 1
    v_mfma_f32_16x16x32_bf16 v[206:209], v[98:101], v[188:191], v[206:209]
    v_mfma_f32_16x16x32_bf16 v[210:213], v[112:115], v[188:191], v[210:213]
    v_mfma_f32_16x16x32_bf16 v[230:233], v[238:241], v[188:191], v[230:233]
    v_cvt_pk_bf16_f32 v197, v196, v197
    v_cvt_pk_bf16_f32 v196, v194, v195
    v_cvt_pk_bf16_f32 v198, v198, v199
    v_cvt_pk_bf16_f32 v199, v200, v201
    s_nop 1
    v_mfma_f32_16x16x32_bf16 v[206:209], v[102:105], v[196:199], v[206:209]
    v_mfma_f32_16x16x32_bf16 v[210:213], v[116:119], v[196:199], v[210:213]
    v_mfma_f32_16x16x32_bf16 v[230:233], v[238:241], v[196:199], v[230:233]
    v_cvt_pk_bf16_f32 v202, v214, 0
    s_nop 2
    v_mfma_f32_16x16x16_bf16 v[206:209], v[106:107], v[202:203], v[206:209]
    v_mfma_f32_16x16x16_bf16 v[210:213], v[120:121], v[202:203], v[210:213]
    v_mfma_f32_16x16x16_bf16 v[230:233], v[238:239], v[202:203], v[230:233]
    s_nop 7
    v_rcp_f32 v231, v230
    s_nop 0
    v_fma_f32 v206, v206, v231, v126
    v_fma_f32 v207, v207, v231, v127
    v_fma_f32 v208, v208, v231, v128
    v_fma_f32 v209, v209, v231, v129
    v_fma_f32 v210, v210, v231, v130
    v_fma_f32 v211, v211, v231, v131
    v_fma_f32 v212, v212, v231, v132
    v_fma_f32 v213, v213, v231, v133
    v_cvt_pk_bf16_f32 v206, v206, v207
    v_cvt_pk_bf16_f32 v207, v208, v209
    v_cvt_pk_bf16_f32 v208, v210, v211
    v_cvt_pk_bf16_f32 v209, v212, v213
    v_pk_max_i16 v206, v206, 0
    v_pk_max_i16 v207, v207, 0
    v_pk_max_i16 v208, v208, 0
    v_pk_max_i16 v209, v209, 0
    s_add_u32 s46, s47, 8192
    buffer_store_dwordx4 v[206:209], v249, s[12:15], s46 offen sc1
    s_add_u32 s45, s47, 10240
    buffer_load_dwordx4 v[134:137], v250, s[8:11], s45 offen
    buffer_load_dwordx4 v[138:141], v250, s[8:11], s45 offen offset:64
    s_waitcnt vmcnt(0)
    v_mfma_f32_16x16x32_bf16 v[158:161], v[2:5], v[134:137], 0
    v_mfma_f32_16x16x32_bf16 v[162:165], v[6:9], v[134:137], 0
    v_mfma_f32_16x16x32_bf16 v[158:161], v[10:13], v[138:141], v[158:161]
    v_mfma_f32_16x16x32_bf16 v[162:165], v[14:17], v[138:141], v[162:165]
    s_nop 6
    v_cvt_pk_bf16_f32 v166, v158, v159
    v_cvt_pk_bf16_f32 v167, v160, v161
    v_cvt_pk_bf16_f32 v168, v162, v163
    v_cvt_pk_bf16_f32 v169, v164, v165
    v_mfma_f32_16x16x32_bf16 v[126:129], v[50:53], v[134:137], 0
    v_mfma_f32_16x16x32_bf16 v[130:133], v[54:57], v[134:137], 0
    v_mfma_f32_16x16x32_bf16 v[126:129], v[58:61], v[138:141], v[126:129]
    v_mfma_f32_16x16x32_bf16 v[130:133], v[62:65], v[138:141], v[130:133]
    v_mfma_f32_16x16x32_bf16 v[178:181], v[66:69], v[166:169], 0
    v_mfma_f32_16x16x32_bf16 v[182:185], v[70:73], v[166:169], 0
    v_mfma_f32_16x16x32_bf16 v[186:189], v[74:77], v[166:169], 0
    v_mfma_f32_16x16x32_bf16 v[190:193], v[78:81], v[166:169], 0
    v_mfma_f32_16x16x32_bf16 v[194:197], v[82:85], v[166:169], 0
    v_mfma_f32_16x16x32_bf16 v[198:201], v[86:89], v[166:169], 0
    v_mfma_f32_16x16x32_bf16 v[214:217], v[90:93], v[166:169], 0
    s_nop 7
    v_mov_b32 v234, v214
    v_max3_f32 v234, v234, v178, v179
    v_max3_f32 v234, v234, v180, v181
    v_max3_f32 v234, v234, v182, v183
    v_max3_f32 v234, v234, v184, v185
    v_max3_f32 v234, v234, v186, v187
    v_max3_f32 v234, v234, v188, v189
    v_max3_f32 v234, v234, v190, v191
    v_max3_f32 v234, v234, v192, v193
    v_max3_f32 v234, v234, v194, v195
    v_max3_f32 v234, v234, v196, v197
    v_max3_f32 v234, v234, v198, v199
    v_max3_f32 v234, v234, v200, v201
    v_mov_b32 v235, v234
    s_nop 1
    v_permlane16_swap_b32 v234, v235
    v_max_f32 v234, v234, v235
    v_mov_b32 v235, v234
    s_nop 1
    v_permlane32_swap_b32 v234, v235
    v_max_f32 v234, v234, v235
    v_sub_f32 v178, v178, v234
    v_exp_f32 v178, v178
    v_sub_f32 v179, v179, v234
    v_exp_f32 v179, v179
    v_sub_f32 v180, v180, v234
    v_exp_f32 v180, v180
    v_sub_f32 v181, v181, v234
    v_exp_f32 v181, v181
    v_sub_f32 v182, v182, v234
    v_exp_f32 v182, v182
    v_sub_f32 v183, v183, v234
    v_exp_f32 v183, v183
    v_sub_f32 v184, v184, v234
    v_exp_f32 v184, v184
    v_sub_f32 v185, v185, v234
    v_exp_f32 v185, v185
    v_sub_f32 v186, v186, v234
    v_exp_f32 v186, v186
    v_sub_f32 v187, v187, v234
    v_exp_f32 v187, v187
    v_sub_f32 v188, v188, v234
    v_exp_f32 v188, v188
    v_sub_f32 v189, v189, v234
    v_exp_f32 v189, v189
    v_sub_f32 v190, v190, v234
    v_exp_f32 v190, v190
    v_sub_f32 v191, v191, v234
    v_exp_f32 v191, v191
    v_sub_f32 v192, v192, v234
    v_exp_f32 v192, v192
    v_sub_f32 v193, v193, v234
    v_exp_f32 v193, v193
    v_sub_f32 v194, v194, v234
    v_exp_f32 v194, v194
    v_sub_f32 v195, v195, v234
    v_exp_f32 v195, v195
    v_sub_f32 v196, v196, v234
    v_exp_f32 v196, v196
    v_sub_f32 v197, v197, v234
    v_exp_f32 v197, v197
    v_sub_f32 v198, v198, v234
    v_exp_f32 v198, v198
    v_sub_f32 v199, v199, v234
    v_exp_f32 v199, v199
    v_sub_f32 v200, v200, v234
    v_exp_f32 v200, v200
    v_sub_f32 v201, v201, v234
    v_exp_f32 v201, v201
    v_sub_f32 v214, v214, v234
    v_exp_f32 v214, v214
    v_cvt_pk_bf16_f32 v181, v180, v181
    v_cvt_pk_bf16_f32 v180, v178, v179
    v_cvt_pk_bf16_f32 v182, v182, v183
    v_cvt_pk_bf16_f32 v183, v184, v185
    s_nop 1
    v_mfma_f32_16x16x32_bf16 v[206:209], v[94:97], v[180:183], 0
    v_mfma_f32_16x16x32_bf16 v[210:213], v[108:111], v[180:183], 0
    v_mfma_f32_16x16x32_bf16 v[230:233], v[238:241], v[180:183], 0
    v_cvt_pk_bf16_f32 v189, v188, v189
    v_cvt_pk_bf16_f32 v188, v186, v187
    v_cvt_pk_bf16_f32 v190, v190, v191
    v_cvt_pk_bf16_f32 v191, v192, v193
    s_nop 1
    v_mfma_f32_16x16x32_bf16 v[206:209], v[98:101], v[188:191], v[206:209]
    v_mfma_f32_16x16x32_bf16 v[210:213], v[112:115], v[188:191], v[210:213]
    v_mfma_f32_16x16x32_bf16 v[230:233], v[238:241], v[188:191], v[230:233]
    v_cvt_pk_bf16_f32 v197, v196, v197
    v_cvt_pk_bf16_f32 v196, v194, v195
    v_cvt_pk_bf16_f32 v198, v198, v199
    v_cvt_pk_bf16_f32 v199, v200, v201
    s_nop 1
    v_mfma_f32_16x16x32_bf16 v[206:209], v[102:105], v[196:199], v[206:209]
    v_mfma_f32_16x16x32_bf16 v[210:213], v[116:119], v[196:199], v[210:213]
    v_mfma_f32_16x16x32_bf16 v[230:233], v[238:241], v[196:199], v[230:233]
    v_cvt_pk_bf16_f32 v202, v214, 0
    s_nop 2
    v_mfma_f32_16x16x16_bf16 v[206:209], v[106:107], v[202:203], v[206:209]
    v_mfma_f32_16x16x16_bf16 v[210:213], v[120:121], v[202:203], v[210:213]
    v_mfma_f32_16x16x16_bf16 v[230:233], v[238:239], v[202:203], v[230:233]
    s_nop 7
    v_rcp_f32 v231, v230
    s_nop 0
    v_fma_f32 v206, v206, v231, v126
    v_fma_f32 v207, v207, v231, v127
    v_fma_f32 v208, v208, v231, v128
    v_fma_f32 v209, v209, v231, v129
    v_fma_f32 v210, v210, v231, v130
    v_fma_f32 v211, v211, v231, v131
    v_fma_f32 v212, v212, v231, v132
    v_fma_f32 v213, v213, v231, v133
    v_cvt_pk_bf16_f32 v206, v206, v207
    v_cvt_pk_bf16_f32 v207, v208, v209
    v_cvt_pk_bf16_f32 v208, v210, v211
    v_cvt_pk_bf16_f32 v209, v212, v213
    v_pk_max_i16 v206, v206, 0
    v_pk_max_i16 v207, v207, 0
    v_pk_max_i16 v208, v208, 0
    v_pk_max_i16 v209, v209, 0
    s_add_u32 s46, s47, 10240
    buffer_store_dwordx4 v[206:209], v249, s[12:15], s46 offen sc1
    s_add_u32 s45, s47, 12288
    buffer_load_dwordx4 v[134:137], v251, s[8:11], s45 offen
    buffer_load_dwordx4 v[138:141], v251, s[8:11], s45 offen offset:64
    s_waitcnt vmcnt(0)
    v_mfma_f32_16x16x32_bf16 v[150:153], v[2:5], v[134:137], 0
    v_mfma_f32_16x16x32_bf16 v[154:157], v[6:9], v[134:137], 0
    v_mfma_f32_16x16x32_bf16 v[150:153], v[10:13], v[138:141], v[150:153]
    v_mfma_f32_16x16x32_bf16 v[154:157], v[14:17], v[138:141], v[154:157]
    s_nop 6
    v_cvt_pk_bf16_f32 v166, v150, v151
    v_cvt_pk_bf16_f32 v167, v152, v153
    v_cvt_pk_bf16_f32 v168, v154, v155
    v_cvt_pk_bf16_f32 v169, v156, v157
    v_mfma_f32_16x16x32_bf16 v[126:129], v[50:53], v[134:137], 0
    v_mfma_f32_16x16x32_bf16 v[130:133], v[54:57], v[134:137], 0
    v_mfma_f32_16x16x32_bf16 v[126:129], v[58:61], v[138:141], v[126:129]
    v_mfma_f32_16x16x32_bf16 v[130:133], v[62:65], v[138:141], v[130:133]
    v_mfma_f32_16x16x32_bf16 v[178:181], v[66:69], v[166:169], 0
    v_mfma_f32_16x16x32_bf16 v[182:185], v[70:73], v[166:169], 0
    v_mfma_f32_16x16x32_bf16 v[186:189], v[74:77], v[166:169], 0
    v_mfma_f32_16x16x32_bf16 v[190:193], v[78:81], v[166:169], 0
    v_mfma_f32_16x16x32_bf16 v[194:197], v[82:85], v[166:169], 0
    v_mfma_f32_16x16x32_bf16 v[198:201], v[86:89], v[166:169], 0
    v_mfma_f32_16x16x32_bf16 v[214:217], v[90:93], v[166:169], 0
    s_nop 7
    v_mov_b32 v234, v214
    v_max3_f32 v234, v234, v178, v179
    v_max3_f32 v234, v234, v180, v181
    v_max3_f32 v234, v234, v182, v183
    v_max3_f32 v234, v234, v184, v185
    v_max3_f32 v234, v234, v186, v187
    v_max3_f32 v234, v234, v188, v189
    v_max3_f32 v234, v234, v190, v191
    v_max3_f32 v234, v234, v192, v193
    v_max3_f32 v234, v234, v194, v195
    v_max3_f32 v234, v234, v196, v197
    v_max3_f32 v234, v234, v198, v199
    v_max3_f32 v234, v234, v200, v201
    v_mov_b32 v235, v234
    s_nop 1
    v_permlane16_swap_b32 v234, v235
    v_max_f32 v234, v234, v235
    v_mov_b32 v235, v234
    s_nop 1
    v_permlane32_swap_b32 v234, v235
    v_max_f32 v234, v234, v235
    v_sub_f32 v178, v178, v234
    v_exp_f32 v178, v178
    v_sub_f32 v179, v179, v234
    v_exp_f32 v179, v179
    v_sub_f32 v180, v180, v234
    v_exp_f32 v180, v180
    v_sub_f32 v181, v181, v234
    v_exp_f32 v181, v181
    v_sub_f32 v182, v182, v234
    v_exp_f32 v182, v182
    v_sub_f32 v183, v183, v234
    v_exp_f32 v183, v183
    v_sub_f32 v184, v184, v234
    v_exp_f32 v184, v184
    v_sub_f32 v185, v185, v234
    v_exp_f32 v185, v185
    v_sub_f32 v186, v186, v234
    v_exp_f32 v186, v186
    v_sub_f32 v187, v187, v234
    v_exp_f32 v187, v187
    v_sub_f32 v188, v188, v234
    v_exp_f32 v188, v188
    v_sub_f32 v189, v189, v234
    v_exp_f32 v189, v189
    v_sub_f32 v190, v190, v234
    v_exp_f32 v190, v190
    v_sub_f32 v191, v191, v234
    v_exp_f32 v191, v191
    v_sub_f32 v192, v192, v234
    v_exp_f32 v192, v192
    v_sub_f32 v193, v193, v234
    v_exp_f32 v193, v193
    v_sub_f32 v194, v194, v234
    v_exp_f32 v194, v194
    v_sub_f32 v195, v195, v234
    v_exp_f32 v195, v195
    v_sub_f32 v196, v196, v234
    v_exp_f32 v196, v196
    v_sub_f32 v197, v197, v234
    v_exp_f32 v197, v197
    v_sub_f32 v198, v198, v234
    v_exp_f32 v198, v198
    v_sub_f32 v199, v199, v234
    v_exp_f32 v199, v199
    v_sub_f32 v200, v200, v234
    v_exp_f32 v200, v200
    v_sub_f32 v201, v201, v234
    v_exp_f32 v201, v201
    v_sub_f32 v214, v214, v234
    v_exp_f32 v214, v214
    v_cvt_pk_bf16_f32 v181, v180, v181
    v_cvt_pk_bf16_f32 v180, v178, v179
    v_cvt_pk_bf16_f32 v182, v182, v183
    v_cvt_pk_bf16_f32 v183, v184, v185
    s_nop 1
    v_mfma_f32_16x16x32_bf16 v[206:209], v[94:97], v[180:183], 0
    v_mfma_f32_16x16x32_bf16 v[210:213], v[108:111], v[180:183], 0
    v_mfma_f32_16x16x32_bf16 v[230:233], v[238:241], v[180:183], 0
    v_cvt_pk_bf16_f32 v189, v188, v189
    v_cvt_pk_bf16_f32 v188, v186, v187
    v_cvt_pk_bf16_f32 v190, v190, v191
    v_cvt_pk_bf16_f32 v191, v192, v193
    s_nop 1
    v_mfma_f32_16x16x32_bf16 v[206:209], v[98:101], v[188:191], v[206:209]
    v_mfma_f32_16x16x32_bf16 v[210:213], v[112:115], v[188:191], v[210:213]
    v_mfma_f32_16x16x32_bf16 v[230:233], v[238:241], v[188:191], v[230:233]
    v_cvt_pk_bf16_f32 v197, v196, v197
    v_cvt_pk_bf16_f32 v196, v194, v195
    v_cvt_pk_bf16_f32 v198, v198, v199
    v_cvt_pk_bf16_f32 v199, v200, v201
    s_nop 1
    v_mfma_f32_16x16x32_bf16 v[206:209], v[102:105], v[196:199], v[206:209]
    v_mfma_f32_16x16x32_bf16 v[210:213], v[116:119], v[196:199], v[210:213]
    v_mfma_f32_16x16x32_bf16 v[230:233], v[238:241], v[196:199], v[230:233]
    v_cvt_pk_bf16_f32 v202, v214, 0
    s_nop 2
    v_mfma_f32_16x16x16_bf16 v[206:209], v[106:107], v[202:203], v[206:209]
    v_mfma_f32_16x16x16_bf16 v[210:213], v[120:121], v[202:203], v[210:213]
    v_mfma_f32_16x16x16_bf16 v[230:233], v[238:239], v[202:203], v[230:233]
    s_nop 7
    v_rcp_f32 v231, v230
    s_nop 0
    v_fma_f32 v206, v206, v231, v126
    v_fma_f32 v207, v207, v231, v127
    v_fma_f32 v208, v208, v231, v128
    v_fma_f32 v209, v209, v231, v129
    v_fma_f32 v210, v210, v231, v130
    v_fma_f32 v211, v211, v231, v131
    v_fma_f32 v212, v212, v231, v132
    v_fma_f32 v213, v213, v231, v133
    v_cvt_pk_bf16_f32 v206, v206, v207
    v_cvt_pk_bf16_f32 v207, v208, v209
    v_cvt_pk_bf16_f32 v208, v210, v211
    v_cvt_pk_bf16_f32 v209, v212, v213
    v_pk_max_i16 v206, v206, 0
    v_pk_max_i16 v207, v207, 0
    v_pk_max_i16 v208, v208, 0
    v_pk_max_i16 v209, v209, 0
    s_add_u32 s46, s47, 12288
    buffer_store_dwordx4 v[206:209], v248, s[12:15], s46 offen sc1
    s_nop 7
    s_add_u32 s47, s47, 13107200
    s_add_u32 s35, s35, 1
    s_cmp_lt_u32 s35, 4
    s_cbranch_scc1 L_safe_loop
    s_branch L_end
.section .rodata,"a"
.p2align 6
.amdhsa_kernel standalone__attention_interact_autoint__recsys_kernel
  .amdhsa_next_free_vgpr 256
  .amdhsa_next_free_sgpr 64
  .amdhsa_accum_offset 256
  .amdhsa_group_segment_fixed_size 0
  .amdhsa_kernarg_size 64
  .amdhsa_user_sgpr_count 2
  .amdhsa_user_sgpr_kernarg_segment_ptr 1
  .amdhsa_system_sgpr_workgroup_id_x 1
.end_amdhsa_kernel
```
